```python
import torch

def _softmax(x, axis=-1):
    return torch.softmax(x, dim=axis)
def _gelu(x):
    return torch.nn.functional.gelu(x, approximate="tanh")
def _silu(x):
    return torch.nn.functional.silu(x)
def _sigmoid(x):
    return torch.sigmoid(x)
def _layernorm(x, axis=-1, eps=1e-5):
    m = x.mean(dim=axis, keepdim=True)
    v = x.var(dim=axis, keepdim=True, unbiased=False)
    return (x - m) / torch.sqrt(v + eps)
def _scatter_add(tgt, idx, src, axis=0):
    return tgt.clone().index_add_(axis, idx, src)
def _segment_sum(src, seg, n):
    out = torch.zeros((n,) + src.shape[1:], dtype=src.dtype)
    return out.index_add_(0, seg, src)
def _pad(x, pw):
    flat = tuple(v for pair in reversed(pw) for v in pair)
    return torch.nn.functional.pad(x, flat)

kernel_name = 'gated_mix__ssm_conv_s4__spectral_gfnet__prompt'

def setup_inputs():

    _w = (lambda a: (lambda t: t.to(torch.bfloat16) if t.is_floating_point() else t)(torch.as_tensor(a)))
    def _A_setup():
        B, L, D, N = 1, 2048, 448, 256
        A_re = -(lambda _x: torch.exp(torch.as_tensor(_x)))((lambda *s: torch.randn(*s, dtype=torch.bfloat16) * 3.2)(D, N))
        A_im = torch.pi * (lambda *s: torch.randn(*s, dtype=torch.bfloat16) * 0.05)(D, N)
        B_re = (lambda *s: torch.randn(*s, dtype=torch.bfloat16) * 0.1)(D, N)
        B_im = (lambda *s: torch.randn(*s, dtype=torch.bfloat16) * 0.1)(D, N)
        C_re = (lambda *s: torch.randn(*s, dtype=torch.bfloat16) * 0.1)(D, N)
        C_im = (lambda *s: torch.randn(*s, dtype=torch.bfloat16) * 0.1)(D, N)
        log_dt = (lambda *s: torch.randn(*s, dtype=torch.bfloat16) * 0.05)(D) * 0.5 - 4.0
        Dskip = (lambda *s: torch.randn(*s, dtype=torch.bfloat16) * 0.05)(D)
        return {
            "u": _w((lambda *s: torch.randn(*s, dtype=torch.bfloat16) * 0.05)(B, L, D)),
            "A_re": _w(A_re),
            "A_im": _w(A_im),
            "B_re": _w(B_re),
            "B_im": _w(B_im),
            "C_re": _w(C_re),
            "C_im": _w(C_im),
            "log_dt": _w(log_dt),
            "Dskip": _w(Dskip),
        }
    _A_in = _A_setup()

    def _B_setup():
        B, S, D = 1, 2048, 448
        Df = D // 2 + 1
        return {
            "x": _w((lambda *s: torch.randn(*s, dtype=torch.bfloat16) * 0.05)(B, S, D)),
            "w_r": _w((lambda *s: torch.randn(*s, dtype=torch.bfloat16) * 1.6)(S, Df) * 0.02),
            "w_i": _w((lambda *s: torch.randn(*s, dtype=torch.bfloat16) * 1.6)(S, Df) * 0.02),
        }
    _B_in = _B_setup()

    return {
        "A_u": _A_in["u"],
        "A_A_re": _A_in["A_re"],
        "A_A_im": _A_in["A_im"],
        "A_B_re": _A_in["B_re"],
        "A_B_im": _A_in["B_im"],
        "A_C_re": _A_in["C_re"],
        "A_C_im": _A_in["C_im"],
        "A_log_dt": _A_in["log_dt"],
        "A_Dskip": _A_in["Dskip"],
        "B_x": _B_in["x"],
        "B_w_r": _B_in["w_r"],
        "B_w_i": _B_in["w_i"],
        "gate_w": _w((lambda *s: torch.randn(*s, dtype=torch.bfloat16) * 0.05)(448) * 16.0),
    }

def reference(A_u, A_A_re, A_A_im, A_B_re, A_B_im, A_C_re, A_C_im, A_log_dt, A_Dskip, B_x, B_w_r, B_w_i, gate_w):
    def _A_ref(u, A_re, A_im, B_re, B_im, C_re, C_im, log_dt, Dskip):
        Bsz, L, D = u.shape
        dt = torch.exp(log_dt)[:, None]
        A = A_re + 1j * A_im
        Bc = B_re + 1j * B_im
        Cc = C_re + 1j * C_im
        logdA = dt * A
        dB = dt * Bc
        l = (lambda x, dt: x.to(dt))(torch.arange(L), A_re.dtype)
        P = torch.exp(logdA[:, :, None] * l[None, None, :])
        K = torch.einsum("dn,dnl,dn->dl", Cc, P, dB).real
        L2 = 2 * L
        Kp = _pad(K, ((0, 0), (0, L)))
        up = (lambda x, *d: x.permute(*d))(u, 0, 2, 1)
        up = _pad(up, ((0, 0), (0, 0), (0, L)))
        Kf = (lambda x, axes=(-2,-1): torch.fft.rfft2(x.float(), dim=axes))(Kp[:, None, :], axes=(-2, -1))
        Uf = (lambda x, axes=(-2,-1): torch.fft.rfft2(x.float(), dim=axes))(up[:, :, None, :], axes=(-2, -1))
        Yf = Uf * Kf[None, :, :, :]
        y = (lambda x, s, axes=(-2,-1): torch.fft.irfft2(x, s=s, dim=axes).to(torch.bfloat16))(Yf, (1, L2), axes=(-2, -1))[:, :, 0, :L]
        y = (lambda x, *d: x.permute(*d))(y, 0, 2, 1) + u * Dskip[None, None, :]
        return y

    def _B_ref(x, w_r, w_i):
        B, S, D = x.shape
        X = (lambda x, axes=(-2,-1): torch.fft.rfft2(x.float(), dim=axes))(x, axes=(-2, -1))
        W = w_r + 1j * w_i
        X = X * W
        y = (lambda x, s, axes=(-2,-1): torch.fft.irfft2(x, s=s, dim=axes).to(torch.bfloat16))(X, (S, D), axes=(-2, -1))
        return y

    x = A_u
    g = _sigmoid((x * gate_w).sum(-1, keepdims=True))
    a = _A_ref(x, A_A_re, A_A_im, A_B_re, A_B_im, A_C_re, A_C_im, A_log_dt, A_Dskip)
    b = _B_ref(x, B_w_r, B_w_i)
    return g * a + (1 - g) * b
```

```asm
; @launch grid=(256,1,1) block=(1024,1,1) lds=145664
.amdgcn_target "amdgcn-amd-amdhsa--gfx950"
.text
.globl gated_mix__ssm_conv_s4__spectral_gfnet__prompt_kernel
.p2align 8
.type gated_mix__ssm_conv_s4__spectral_gfnet__prompt_kernel,@function
gated_mix__ssm_conv_s4__spectral_gfnet__prompt_kernel:
    s_cmp_ge_u32 s2, 256
    s_cbranch_scc1 gated_mix__ssm_conv_s4__spectral_gfnet__prompt_kernel_end
    v_lshrrev_b32 v1, 6, v0
    v_and_b32 v0, 63, v0
    v_readfirstlane_b32 s3, v1
    s_load_dwordx2 s[60:61], s[0:1], 112
    s_load_dwordx2 s[24:25], s[0:1], 120
    v_mov_b32 v126, 1
    v_mov_b32 v127, 0
    s_cmp_lt_u32 s3, 8
    s_cbranch_scc1 gated_mix__ssm_conv_s4__spectral_gfnet__prompt_kernel_A
    s_cmp_ge_u32 s3, 12
    s_cbranch_scc1 gated_mix__ssm_conv_s4__spectral_gfnet__prompt_kernel_T
    s_branch gated_mix__ssm_conv_s4__spectral_gfnet__prompt_kernel_B
gated_mix__ssm_conv_s4__spectral_gfnet__prompt_kernel_A:
    s_and_b32 s26, s2, 7
    s_cmp_eq_u32 s26, 7
    s_cbranch_scc1 gated_mix__ssm_conv_s4__spectral_gfnet__prompt_kernel_end
    s_load_dwordx16 s[8:23], s[0:1], 8
    s_lshr_b32 s4, s3, 2
    s_lshl_b32 s5, s26, 6
    s_lshr_b32 s27, s2, 3
    s_lshl_b32 s27, s27, 1
    s_add_u32 s5, s5, s27
    s_lshr_b32 s28, s5, 1
    s_lshl_b32 s28, s28, 2
    s_add_u32 s5, s5, s4
    s_and_b32 s6, s3, 3
    s_lshl_b32 s7, s5, 9
    s_lshl_b32 s26, s6, 7
    s_add_u32 s7, s7, s26
    v_lshl_add_u32 v1, v0, 1, s7
    s_mul_i32 s29, s3, 6144
    s_add_u32 s29, s29, 256
    s_lshl_b32 s56, s4, 2
    s_waitcnt lgkmcnt(0)
    s_load_dword s27, s[20:21], s28
    s_load_dword s55, s[22:23], s28
    global_load_ushort v2, v1, s[8:9]
    global_load_ushort v3, v1, s[10:11]
    global_load_ushort v4, v1, s[12:13]
    global_load_ushort v5, v1, s[14:15]
    global_load_ushort v6, v1, s[16:17]
    global_load_ushort v7, v1, s[18:19]
    v_lshl_add_u32 v60, v0, 2, s29
    v_and_b32 v8, 15, v0
    v_lshrrev_b32 v9, 4, v0
    v_mul_u32_u24 v10, 288, v8
    v_lshl_add_u32 v10, v9, 4, v10
    v_add_u32 v61, s29, v10
    v_add_u32 v10, 16, v8
    v_min_u32 v10, 20, v10
    v_mul_u32_u24 v10, 288, v10
    v_lshl_add_u32 v10, v9, 4, v10
    v_add_u32 v62, s29, v10
    v_lshl_add_u32 v64, v0, 4, s29
    s_mul_i32 s30, s4, 24576
    s_add_u32 s30, s30, 256
    s_mul_i32 s31, s4, 2560
    s_add_u32 s31, s31, 114816
    s_lshl_b32 s33, s6, 6
    v_add_u32 v11, s33, v0
    v_lshrrev_b32 v12, 5, v11
    v_mov_b32 v14, 16
    v_lshrrev_b32 v13, v12, v14
    v_sub_u32 v13, 16, v13
    v_add_u32 v14, 12, v12
    v_cmp_gt_u32 vcc, 4, v12
    s_nop 1
    v_cndmask_b32 v13, v14, v13, vcc
    v_and_b32 v14, 31, v11
    v_mul_u32_u24 v14, 80, v14
    v_lshl_add_u32 v14, v13, 1, v14
    v_add_u32 v65, s31, v14
    v_add_u32 v15, 1, v11
    v_lshrrev_b32 v12, 5, v15
    v_mov_b32 v14, 16
    v_lshrrev_b32 v13, v12, v14
    v_sub_u32 v13, 16, v13
    v_add_u32 v14, 12, v12
    v_cmp_gt_u32 vcc, 4, v12
    s_nop 1
    v_cndmask_b32 v13, v14, v13, vcc
    v_and_b32 v14, 31, v15
    v_mul_u32_u24 v14, 80, v14
    v_lshl_add_u32 v14, v13, 1, v14
    v_add_u32 v66, s31, v14
    s_cmp_lg_u32 s6, 0
    s_cbranch_scc1 gated_mix__ssm_conv_s4__spectral_gfnet__prompt_kernel_a_nz
    v_mov_b32 v12, 0
    v_mov_b32 v13, 0
    v_mov_b32 v14, 0
    v_mov_b32 v15, 0
    s_mul_i32 s33, s4, 4608
    s_add_u32 s33, s33, 105600
    v_lshl_add_u32 v16, v0, 4, s33
    s_mov_b32 exec_hi, 0
    ds_write_b128 v16, v[12:15]
    s_mov_b64 exec, -1
gated_mix__ssm_conv_s4__spectral_gfnet__prompt_kernel_a_nz:
    s_barrier
    s_waitcnt lgkmcnt(0)
    s_lshl_b32 s34, s27, 16
    s_and_b32 s35, s27, 0xffff0000
    s_cmp_eq_u32 s4, 0
    s_cselect_b32 s34, s34, s35
    s_lshl_b32 s36, s55, 16
    s_and_b32 s35, s55, 0xffff0000
    s_cmp_eq_u32 s4, 0
    s_cselect_b32 s55, s36, s35
    v_mov_b32 v8, s34
    v_mul_f32 v8, 0x3fb8aa3b, v8
    v_exp_f32 v8, v8
    s_nop 0
    v_cvt_pk_bf16_f32 v8, v8, v8
    v_lshlrev_b32 v8, 16, v8
    s_waitcnt vmcnt(0)
    v_lshlrev_b32 v2, 16, v2
    v_lshlrev_b32 v3, 16, v3
    v_lshlrev_b32 v4, 16, v4
    v_lshlrev_b32 v5, 16, v5
    v_lshlrev_b32 v6, 16, v6
    v_lshlrev_b32 v7, 16, v7
    v_mul_f32 v10, v8, v2
    v_mul_f32 v10, 0x3fb8aa3b, v10
    v_mul_f32 v11, v8, v3
    v_mul_f32 v11, 0.15915494, v11
    v_mul_f32 v12, v8, v4
    v_mul_f32 v13, v8, v5
    v_mov_b32 v14, v6
    v_mov_b32 v15, v7
    v_pk_mul_f32 v[16:17], v[14:15], v[12:13] op_sel:[0,0] op_sel_hi:[1,0]
    v_pk_fma_f32 v[16:17], v[14:15], v[12:13], v[16:17] op_sel:[1,1,0] op_sel_hi:[0,1,1] neg_lo:[1,0,0]
    v_exp_f32 v2, v10
    v_fract_f32 v3, v11
    v_cos_f32 v4, v3
    v_sin_f32 v5, v3
    v_mul_f32 v18, v2, v4
    v_mul_f32 v19, v2, v5
    v_mul_f32 v2, 0x43800000, v10
    v_mul_f32 v3, 0x43800000, v11
    v_exp_f32 v2, v2
    v_fract_f32 v3, v3
    v_cos_f32 v4, v3
    v_sin_f32 v5, v3
    v_mul_f32 v22, v2, v4
    v_mul_f32 v23, v2, v5
    v_mul_f32 v2, 0x41000000, v10
    v_mul_f32 v3, 0x41000000, v11
    v_exp_f32 v2, v2
    v_fract_f32 v3, v3
    v_cos_f32 v4, v3
    v_sin_f32 v5, v3
    v_mul_f32 v20, v2, v4
    v_mul_f32 v21, v2, v5
    v_mov_b32 v50, v60
    v_mov_b32 v30, 0x3f80
    v_cvt_pk_bf16_f32 v31, v18, -v19
    ds_write2_b32 v50, v30, v31 offset0:0 offset1:72
    v_pk_mul_f32 v[34:35], v[18:19], v[18:19] op_sel:[0,0] op_sel_hi:[1,0]
    v_pk_fma_f32 v[34:35], v[18:19], v[18:19], v[34:35] op_sel:[1,1,0] op_sel_hi:[0,1,1] neg_lo:[1,0,0]
    v_pk_mul_f32 v[36:37], v[34:35], v[18:19] op_sel:[0,0] op_sel_hi:[1,0]
    v_pk_fma_f32 v[36:37], v[34:35], v[18:19], v[36:37] op_sel:[1,1,0] op_sel_hi:[0,1,1] neg_lo:[1,0,0]
    v_cvt_pk_bf16_f32 v32, v34, -v35
    v_cvt_pk_bf16_f32 v33, v36, -v37
    ds_write2_b32 v50, v32, v33 offset0:144 offset1:216
    v_add_u32 v50, 1152, v50
    v_pk_mul_f32 v[38:39], v[34:35], v[34:35] op_sel:[0,0] op_sel_hi:[1,0]
    v_pk_fma_f32 v[38:39], v[34:35], v[34:35], v[38:39] op_sel:[1,1,0] op_sel_hi:[0,1,1] neg_lo:[1,0,0]
    v_pk_mul_f32 v[42:43], v[38:39], v[18:19] op_sel:[0,0] op_sel_hi:[1,0]
    v_pk_fma_f32 v[42:43], v[38:39], v[18:19], v[42:43] op_sel:[1,1,0] op_sel_hi:[0,1,1] neg_lo:[1,0,0]
    v_cvt_pk_bf16_f32 v30, v38, -v39
    v_cvt_pk_bf16_f32 v31, v42, -v43
    ds_write2_b32 v50, v30, v31 offset0:0 offset1:72
    v_pk_mul_f32 v[40:41], v[38:39], v[34:35] op_sel:[0,0] op_sel_hi:[1,0]
    v_pk_fma_f32 v[40:41], v[38:39], v[34:35], v[40:41] op_sel:[1,1,0] op_sel_hi:[0,1,1] neg_lo:[1,0,0]
    v_pk_mul_f32 v[42:43], v[38:39], v[36:37] op_sel:[0,0] op_sel_hi:[1,0]
    v_pk_fma_f32 v[42:43], v[38:39], v[36:37], v[42:43] op_sel:[1,1,0] op_sel_hi:[0,1,1] neg_lo:[1,0,0]
    v_cvt_pk_bf16_f32 v32, v40, -v41
    v_cvt_pk_bf16_f32 v33, v42, -v43
    ds_write2_b32 v50, v32, v33 offset0:144 offset1:216
    v_add_u32 v50, 1152, v50
    v_pk_mul_f32 v[42:43], v[22:23], v[34:35] op_sel:[0,0] op_sel_hi:[1,0]
    v_pk_fma_f32 v[42:43], v[22:23], v[34:35], v[42:43] op_sel:[1,1,0] op_sel_hi:[0,1,1] neg_lo:[1,0,0]
    v_cvt_pk_bf16_f32 v30, v22, -v23
    v_cvt_pk_bf16_f32 v31, v42, -v43
    ds_write2_b32 v50, v30, v31 offset0:0 offset1:72
    v_pk_mul_f32 v[42:43], v[22:23], v[38:39] op_sel:[0,0] op_sel_hi:[1,0]
    v_pk_fma_f32 v[42:43], v[22:23], v[38:39], v[42:43] op_sel:[1,1,0] op_sel_hi:[0,1,1] neg_lo:[1,0,0]
    v_pk_mul_f32 v[36:37], v[22:23], v[40:41] op_sel:[0,0] op_sel_hi:[1,0]
    v_pk_fma_f32 v[36:37], v[22:23], v[40:41], v[36:37] op_sel:[1,1,0] op_sel_hi:[0,1,1] neg_lo:[1,0,0]
    v_cvt_pk_bf16_f32 v32, v42, -v43
    v_cvt_pk_bf16_f32 v33, v36, -v37
    ds_write2_b32 v50, v32, v33 offset0:144 offset1:216
    v_add_u32 v50, 1152, v50
    v_pk_mul_f32 v[44:45], v[22:23], v[22:23] op_sel:[0,0] op_sel_hi:[1,0]
    v_pk_fma_f32 v[44:45], v[22:23], v[22:23], v[44:45] op_sel:[1,1,0] op_sel_hi:[0,1,1] neg_lo:[1,0,0]
    v_pk_mul_f32 v[42:43], v[44:45], v[38:39] op_sel:[0,0] op_sel_hi:[1,0]
    v_pk_fma_f32 v[42:43], v[44:45], v[38:39], v[42:43] op_sel:[1,1,0] op_sel_hi:[0,1,1] neg_lo:[1,0,0]
    v_cvt_pk_bf16_f32 v30, v44, -v45
    v_cvt_pk_bf16_f32 v31, v42, -v43
    ds_write2_b32 v50, v30, v31 offset0:0 offset1:72
    v_pk_mul_f32 v[46:47], v[44:45], v[22:23] op_sel:[0,0] op_sel_hi:[1,0]
    v_pk_fma_f32 v[46:47], v[44:45], v[22:23], v[46:47] op_sel:[1,1,0] op_sel_hi:[0,1,1] neg_lo:[1,0,0]
    v_pk_mul_f32 v[42:43], v[46:47], v[38:39] op_sel:[0,0] op_sel_hi:[1,0]
    v_pk_fma_f32 v[42:43], v[46:47], v[38:39], v[42:43] op_sel:[1,1,0] op_sel_hi:[0,1,1] neg_lo:[1,0,0]
    v_cvt_pk_bf16_f32 v32, v46, -v47
    v_cvt_pk_bf16_f32 v33, v42, -v43
    ds_write2_b32 v50, v32, v33 offset0:144 offset1:216
    v_add_u32 v50, 1152, v50
    v_pk_mul_f32 v[48:49], v[44:45], v[44:45] op_sel:[0,0] op_sel_hi:[1,0]
    v_pk_fma_f32 v[48:49], v[44:45], v[44:45], v[48:49] op_sel:[1,1,0] op_sel_hi:[0,1,1] neg_lo:[1,0,0]
    v_pk_mul_f32 v[42:43], v[48:49], v[22:23] op_sel:[0,0] op_sel_hi:[1,0]
    v_pk_fma_f32 v[42:43], v[48:49], v[22:23], v[42:43] op_sel:[1,1,0] op_sel_hi:[0,1,1] neg_lo:[1,0,0]
    v_cvt_pk_bf16_f32 v30, v48, -v49
    v_cvt_pk_bf16_f32 v31, v42, -v43
    ds_write2_b32 v50, v30, v31 offset0:0 offset1:72
    v_pk_mul_f32 v[42:43], v[48:49], v[44:45] op_sel:[0,0] op_sel_hi:[1,0]
    v_pk_fma_f32 v[42:43], v[48:49], v[44:45], v[42:43] op_sel:[1,1,0] op_sel_hi:[0,1,1] neg_lo:[1,0,0]
    v_pk_mul_f32 v[36:37], v[48:49], v[46:47] op_sel:[0,0] op_sel_hi:[1,0]
    v_pk_fma_f32 v[36:37], v[48:49], v[46:47], v[36:37] op_sel:[1,1,0] op_sel_hi:[0,1,1] neg_lo:[1,0,0]
    v_cvt_pk_bf16_f32 v32, v42, -v43
    v_cvt_pk_bf16_f32 v33, v36, -v37
    ds_write2_b32 v50, v32, v33 offset0:144 offset1:216
    v_add_u32 v50, 1152, v50
    v_pk_mul_f32 v[42:43], v[48:49], v[48:49] op_sel:[0,0] op_sel_hi:[1,0]
    v_pk_fma_f32 v[42:43], v[48:49], v[48:49], v[42:43] op_sel:[1,1,0] op_sel_hi:[0,1,1] neg_lo:[1,0,0]
    v_cvt_pk_bf16_f32 v30, v42, -v43
    ds_write_b32 v50, v30
    ds_read_b128 v[68:71], v61 offset:0
    ds_read_b128 v[72:75], v61 offset:64
    ds_read_b128 v[76:79], v61 offset:128
    ds_read_b128 v[80:83], v61 offset:192
    ds_read_b128 v[84:87], v62 offset:0
    ds_read_b128 v[88:91], v62 offset:64
    ds_read_b128 v[92:95], v62 offset:128
    ds_read_b128 v[96:99], v62 offset:192
    v_pk_mul_f32 v[24:25], v[16:17], v[20:21] op_sel:[0,0] op_sel_hi:[1,0]
    v_pk_fma_f32 v[24:25], v[16:17], v[20:21], v[24:25] op_sel:[1,1,0] op_sel_hi:[0,1,1] neg_lo:[1,0,0]
    v_pk_mul_f32 v[28:29], v[20:21], v[20:21] op_sel:[0,0] op_sel_hi:[1,0]
    v_pk_fma_f32 v[28:29], v[20:21], v[20:21], v[28:29] op_sel:[1,1,0] op_sel_hi:[0,1,1] neg_lo:[1,0,0]
    v_mov_b32 v50, v60
    s_mov_b32 s37, 4
Lf1:
    v_cvt_pk_bf16_f32 v52, v16, v17
    v_cvt_pk_bf16_f32 v53, v24, v25
    v_pk_mul_f32 v[26:27], v[16:17], v[28:29] op_sel:[0,0] op_sel_hi:[1,0]
    v_pk_fma_f32 v[16:17], v[16:17], v[28:29], v[26:27] op_sel:[1,1,0] op_sel_hi:[0,1,1] neg_lo:[1,0,0]
    ds_write2_b32 v50, v52, v53 offset0:0 offset1:72
    v_pk_mul_f32 v[26:27], v[24:25], v[28:29] op_sel:[0,0] op_sel_hi:[1,0]
    v_pk_fma_f32 v[24:25], v[24:25], v[28:29], v[26:27] op_sel:[1,1,0] op_sel_hi:[0,1,1] neg_lo:[1,0,0]
    v_cvt_pk_bf16_f32 v54, v16, v17
    v_cvt_pk_bf16_f32 v55, v24, v25
    v_pk_mul_f32 v[26:27], v[16:17], v[28:29] op_sel:[0,0] op_sel_hi:[1,0]
    v_pk_fma_f32 v[16:17], v[16:17], v[28:29], v[26:27] op_sel:[1,1,0] op_sel_hi:[0,1,1] neg_lo:[1,0,0]
    ds_write2_b32 v50, v54, v55 offset0:144 offset1:216
    v_pk_mul_f32 v[26:27], v[24:25], v[28:29] op_sel:[0,0] op_sel_hi:[1,0]
    v_pk_fma_f32 v[24:25], v[24:25], v[28:29], v[26:27] op_sel:[1,1,0] op_sel_hi:[0,1,1] neg_lo:[1,0,0]
    v_add_u32 v50, 1152, v50
    s_sub_u32 s37, s37, 1
    s_cmp_lg_u32 s37, 0
    s_cbranch_scc1 Lf1
    ds_read_b128 v[100:103], v61 offset:0
    ds_read_b128 v[104:107], v61 offset:64
    ds_read_b128 v[108:111], v61 offset:128
    ds_read_b128 v[112:115], v61 offset:192
    s_waitcnt lgkmcnt(3)
    v_mfma_f32_16x16x32_bf16 v[32:35], v[68:71], v[100:103], 0
    v_mfma_f32_16x16x32_bf16 v[40:43], v[84:87], v[100:103], 0
    s_waitcnt lgkmcnt(2)
    v_mfma_f32_16x16x32_bf16 v[32:35], v[72:75], v[104:107], v[32:35]
    v_mfma_f32_16x16x32_bf16 v[40:43], v[88:91], v[104:107], v[40:43]
    s_waitcnt lgkmcnt(1)
    v_mfma_f32_16x16x32_bf16 v[32:35], v[76:79], v[108:111], v[32:35]
    v_mfma_f32_16x16x32_bf16 v[40:43], v[92:95], v[108:111], v[40:43]
    s_waitcnt lgkmcnt(0)
    v_mfma_f32_16x16x32_bf16 v[32:35], v[80:83], v[112:115], v[32:35]
    v_mfma_f32_16x16x32_bf16 v[40:43], v[96:99], v[112:115], v[40:43]
    v_mov_b32 v50, v60
    s_mov_b32 s37, 4
Lf2:
    v_cvt_pk_bf16_f32 v52, v16, v17
    v_cvt_pk_bf16_f32 v53, v24, v25
    v_pk_mul_f32 v[26:27], v[16:17], v[28:29] op_sel:[0,0] op_sel_hi:[1,0]
    v_pk_fma_f32 v[16:17], v[16:17], v[28:29], v[26:27] op_sel:[1,1,0] op_sel_hi:[0,1,1] neg_lo:[1,0,0]
    ds_write2_b32 v50, v52, v53 offset0:0 offset1:72
    v_pk_mul_f32 v[26:27], v[24:25], v[28:29] op_sel:[0,0] op_sel_hi:[1,0]
    v_pk_fma_f32 v[24:25], v[24:25], v[28:29], v[26:27] op_sel:[1,1,0] op_sel_hi:[0,1,1] neg_lo:[1,0,0]
    v_cvt_pk_bf16_f32 v54, v16, v17
    v_cvt_pk_bf16_f32 v55, v24, v25
    v_pk_mul_f32 v[26:27], v[16:17], v[28:29] op_sel:[0,0] op_sel_hi:[1,0]
    v_pk_fma_f32 v[16:17], v[16:17], v[28:29], v[26:27] op_sel:[1,1,0] op_sel_hi:[0,1,1] neg_lo:[1,0,0]
    ds_write2_b32 v50, v54, v55 offset0:144 offset1:216
    v_pk_mul_f32 v[26:27], v[24:25], v[28:29] op_sel:[0,0] op_sel_hi:[1,0]
    v_pk_fma_f32 v[24:25], v[24:25], v[28:29], v[26:27] op_sel:[1,1,0] op_sel_hi:[0,1,1] neg_lo:[1,0,0]
    v_add_u32 v50, 1152, v50
    s_sub_u32 s37, s37, 1
    s_cmp_lg_u32 s37, 0
    s_cbranch_scc1 Lf2
    ds_read_b128 v[100:103], v61 offset:0
    ds_read_b128 v[104:107], v61 offset:64
    ds_read_b128 v[108:111], v61 offset:128
    ds_read_b128 v[112:115], v61 offset:192
    s_waitcnt lgkmcnt(3)
    v_mfma_f32_16x16x32_bf16 v[36:39], v[68:71], v[100:103], 0
    v_mfma_f32_16x16x32_bf16 v[44:47], v[84:87], v[100:103], 0
    s_waitcnt lgkmcnt(2)
    v_mfma_f32_16x16x32_bf16 v[36:39], v[72:75], v[104:107], v[36:39]
    v_mfma_f32_16x16x32_bf16 v[44:47], v[88:91], v[104:107], v[44:47]
    s_waitcnt lgkmcnt(1)
    v_mfma_f32_16x16x32_bf16 v[36:39], v[76:79], v[108:111], v[36:39]
    v_mfma_f32_16x16x32_bf16 v[44:47], v[92:95], v[108:111], v[44:47]
    s_waitcnt lgkmcnt(0)
    v_mfma_f32_16x16x32_bf16 v[36:39], v[80:83], v[112:115], v[36:39]
    v_mfma_f32_16x16x32_bf16 v[44:47], v[96:99], v[112:115], v[44:47]
    ds_write_b128 v64, v[32:35] offset:0
    s_nop 5
    ds_write_b128 v64, v[36:39] offset:1024
    ds_write_b128 v64, v[40:43] offset:2048
    ds_write_b128 v64, v[44:47] offset:3072
    s_waitcnt lgkmcnt(0)
    v_mov_b32 v125, s56
    s_mov_b64 exec, 1
    ds_add_u32 v125, v126 offset:36
    s_mov_b64 exec, -1
    v_mov_b32 v125, s56
    s_mov_b32 s59, 0
Lw3:
    ds_read_b32 v124, v125 offset:36
    s_waitcnt lgkmcnt(0)
    v_readfirstlane_b32 s58, v124
    s_nop 3
    s_cmp_ge_u32 s58, 4
    s_cbranch_scc1 Le4
    s_add_u32 s59, s59, 1
    s_cmp_gt_u32 s59, 2097152
    s_cbranch_scc1 Le4
    s_sleep 1
    s_branch Lw3
Le4:
    s_lshl_b32 s33, s6, 10
    s_add_u32 s33, s33, s30
    v_lshl_add_u32 v2, v0, 4, s33
    ds_read_b128 v[4:7], v2
    ds_read_b128 v[8:11], v2 offset:6144
    ds_read_b128 v[12:15], v2 offset:12288
    ds_read_b128 v[16:19], v2 offset:18432
    v_and_b32 v20, 15, v0
    s_and_b32 s33, s6, 1
    s_lshl_b32 s33, s33, 4
    v_add_u32 v20, s33, v20
    v_mul_u32_u24 v20, 80, v20
    v_lshrrev_b32 v21, 4, v0
    v_lshl_add_u32 v20, v21, 3, v20
    s_lshr_b32 s33, s6, 1
    s_lshl_b32 s33, s33, 5
    s_add_u32 s33, s33, s31
    v_add_u32 v20, s33, v20
    s_waitcnt lgkmcnt(2)
    v_pk_add_f32 v[4:5], v[4:5], v[8:9]
    v_pk_add_f32 v[6:7], v[6:7], v[10:11]
    s_waitcnt lgkmcnt(0)
    v_pk_add_f32 v[12:13], v[12:13], v[16:17]
    v_pk_add_f32 v[14:15], v[14:15], v[18:19]
    v_pk_add_f32 v[4:5], v[4:5], v[12:13]
    v_pk_add_f32 v[6:7], v[6:7], v[14:15]
    v_cvt_pk_bf16_f32 v4, v4, v5
    v_cvt_pk_bf16_f32 v5, v6, v7
    ds_write_b64 v20, v[4:5]
    s_waitcnt lgkmcnt(0)
    v_mov_b32 v125, s56
    s_mov_b64 exec, 1
    ds_add_u32 v125, v126 offset:44
    s_mov_b64 exec, -1
    v_mov_b32 v125, s56
    s_mov_b32 s59, 0
Lw5:
    ds_read_b32 v124, v125 offset:44
    s_waitcnt lgkmcnt(0)
    v_readfirstlane_b32 s58, v124
    s_nop 3
    s_cmp_ge_u32 s58, 4
    s_cbranch_scc1 Le6
    s_add_u32 s59, s59, 1
    s_cmp_gt_u32 s59, 2097152
    s_cbranch_scc1 Le6
    s_sleep 1
    s_branch Lw5
Le6:
    s_mov_b32 s40, 0x01000100
    s_mov_b32 s41, 0x03020302
    s_mov_b32 s42, 0x05040302
    s_mov_b32 s43, 0x05040100
    ds_read_u16 v9, v66
    s_cmp_eq_u32 s6, 0
    s_cbranch_scc1 gated_mix__ssm_conv_s4__spectral_gfnet__prompt_kernel_kx0
    s_cmp_eq_u32 s6, 1
    s_cbranch_scc1 gated_mix__ssm_conv_s4__spectral_gfnet__prompt_kernel_kx1
    ds_read_u16 v8, v65
    v_and_b32 v10, 1, v0
    v_cmp_eq_u32 vcc, 1, v10
    s_waitcnt lgkmcnt(0)
    v_perm_b32 v4, v8, v8, s40
    v_cndmask_b32 v10, v8, v9, vcc
    v_perm_b32 v7, v9, v9, s40
    v_mov_b32 v5, v4
    v_perm_b32 v6, v9, v10, s43
    s_branch gated_mix__ssm_conv_s4__spectral_gfnet__prompt_kernel_kxs
gated_mix__ssm_conv_s4__spectral_gfnet__prompt_kernel_kx1:
    ds_read_b32 v8, v65
    s_waitcnt lgkmcnt(0)
    v_perm_b32 v4, v8, v8, s40
    v_mov_b32 v5, v8
    v_perm_b32 v6, v8, v8, s41
    v_perm_b32 v7, v9, v9, s40
    s_branch gated_mix__ssm_conv_s4__spectral_gfnet__prompt_kernel_kxs
gated_mix__ssm_conv_s4__spectral_gfnet__prompt_kernel_kx0:
    ds_read_b128 v[12:15], v65
    v_cmp_gt_u32 vcc, 32, v0
    s_waitcnt lgkmcnt(0)
    v_perm_b32 v4, v12, v12, s40
    v_perm_b32 v5, v13, v12, s42
    v_perm_b32 v6, v13, v13, s40
    v_perm_b32 v7, v9, v13, s42
    v_cndmask_b32 v4, v4, v12, vcc
    v_cndmask_b32 v5, v5, v13, vcc
    v_cndmask_b32 v6, v6, v14, vcc
    v_cndmask_b32 v7, v7, v15, vcc
gated_mix__ssm_conv_s4__spectral_gfnet__prompt_kernel_kxs:
    s_mul_i32 s33, s4, 4608
    s_lshl_b32 s34, s6, 10
    s_add_u32 s33, s33, s34
    s_add_u32 s33, s33, 106112
    v_lshl_add_u32 v2, v0, 4, s33
    ds_write_b128 v2, v[4:7]
    s_waitcnt lgkmcnt(0)
    v_mov_b32 v125, s56
    s_mov_b64 exec, 1
    ds_add_u32 v125, v126 offset:52
    s_mov_b64 exec, -1
    s_add_u32 s33, s3, 2
    s_and_b32 s33, s33, 7
    s_cmp_lt_u32 s33, 4
    s_cbranch_scc1 gated_mix__ssm_conv_s4__spectral_gfnet__prompt_kernel_conv
    s_mov_b32 s59, 0
Lw7:
    ds_read_b32 v124, v127 offset:96
    s_waitcnt lgkmcnt(0)
    v_readfirstlane_b32 s58, v124
    s_nop 3
    s_cmp_ge_u32 s58, 1
    s_cbranch_scc1 Le8
    s_add_u32 s59, s59, 1
    s_cmp_gt_u32 s59, 2097152
    s_cbranch_scc1 Le8
    s_sleep 1
    s_branch Lw7
Le8:
    s_mov_b32 s12, s24
    s_and_b32 s13, s25, 0xffff
    s_mov_b32 s14, 16777216
    s_mov_b32 s15, 0x00020000
    s_sub_u32 s33, s3, 2
    s_lshr_b32 s34, s33, 1
    s_sub_u32 s26, s5, s4
    s_add_u32 s26, s26, s34
    s_mul_i32 s26, s26, 4112
    s_and_b32 s28, s33, 1
    s_lshl_b32 s28, s28, 11
    s_add_u32 s26, s26, s28
    s_add_u32 s26, s26, 4194304
    s_mul_i32 s27, s34, 8320
    s_add_u32 s27, s27, s28
    s_add_u32 s27, s27, 88960
    v_lshlrev_b32 v1, 4, v0
    v_add_u32 v6, s27, v1
    s_add_u32 s31, s26, 0
    s_add_u32 m0, s27, 0
    s_nop 0
    buffer_load_dwordx4 v1, s[12:15], s31 offen sc1 lds
    s_add_u32 s31, s26, 1024
    s_add_u32 m0, s27, 1024
    s_nop 0
    buffer_load_dwordx4 v1, s[12:15], s31 offen sc1 lds
    s_add_u32 s31, s26, 2048
    s_add_u32 m0, s27, 2048
    s_mov_b64 exec, 1
    buffer_load_dwordx4 v1, s[12:15], s31 offen sc1 lds
    s_mov_b64 exec, -1
    s_waitcnt vmcnt(0)
    ds_read_b128 v[8:11], v6
    ds_read_b32 v12, v6 offset:16
    ds_read_b128 v[16:19], v6 offset:1024
    ds_read_b32 v20, v6 offset:1040
    s_waitcnt lgkmcnt(2)
    v_alignbyte_b32 v8, v9, v8, 2
    v_alignbyte_b32 v9, v10, v9, 2
    v_alignbyte_b32 v10, v11, v10, 2
    v_alignbyte_b32 v11, v12, v11, 2
    ds_write_b128 v6, v[8:11] offset:4160
    s_waitcnt lgkmcnt(1)
    v_alignbyte_b32 v16, v17, v16, 2
    v_alignbyte_b32 v17, v18, v17, 2
    v_alignbyte_b32 v18, v19, v18, 2
    v_alignbyte_b32 v19, v20, v19, 2
    ds_write_b128 v6, v[16:19] offset:5184
    s_waitcnt lgkmcnt(0)
    s_mov_b64 exec, 1
    ds_add_u32 v127, v126 offset:28
    s_mov_b64 exec, -1
    s_endpgm
gated_mix__ssm_conv_s4__spectral_gfnet__prompt_kernel_conv:
    s_and_b32 s6, s3, 1
    s_mul_i32 s7, s4, 8320
    s_add_u32 s7, s7, 88960
    s_mul_i32 s29, s4, 4608
    s_add_u32 s29, s29, 105600
    v_lshlrev_b32 v1, 4, v0
    v_and_b32 v10, 15, v0
    v_lshrrev_b32 v11, 4, v0
    v_lshrrev_b32 v12, 1, v11
    v_and_b32 v13, 1, v11
    v_lshlrev_b32 v14, 4, v13
    v_lshlrev_b32 v15, 5, v12
    v_sub_u32 v14, v14, v15
    v_and_b32 v15, 1, v10
    v_xor_b32 v15, 1, v15
    v_mul_u32_u24 v15, 4160, v15
    v_lshrrev_b32 v16, 1, v10
    v_lshlrev_b32 v16, 2, v16
    v_sub_u32 v15, v15, v16
    v_add_u32 v15, v15, v14
    s_lshl_b32 s31, s6, 8
    s_sub_u32 s33, s7, s31
    s_add_u32 s34, s33, 508
    v_add_u32 v4, s34, v15
    v_add_u32 v5, 1024, v4
    v_add_u32 v6, 2048, v4
    v_add_u32 v7, 3072, v4
    v_lshl_add_u32 v16, v10, 5, v14
    s_sub_u32 s33, s29, s31
    s_add_u32 s34, s33, 512
    v_add_u32 v9, s34, v16
    v_mov_b32 v60, 0
    v_mov_b32 v61, 0
    v_mov_b32 v62, 0
    v_mov_b32 v63, 0
    v_mov_b32 v64, 0
    v_mov_b32 v65, 0
    v_mov_b32 v66, 0
    v_mov_b32 v67, 0
    v_mov_b32 v68, 0
    v_mov_b32 v69, 0
    v_mov_b32 v70, 0
    v_mov_b32 v71, 0
    v_mov_b32 v72, 0
    v_mov_b32 v73, 0
    v_mov_b32 v74, 0
    v_mov_b32 v75, 0
    v_mov_b32 v76, 0
    v_mov_b32 v77, 0
    v_mov_b32 v78, 0
    v_mov_b32 v79, 0
    v_mov_b32 v80, 0
    v_mov_b32 v81, 0
    v_mov_b32 v82, 0
    v_mov_b32 v83, 0
    v_mov_b32 v84, 0
    v_mov_b32 v85, 0
    v_mov_b32 v86, 0
    v_mov_b32 v87, 0
    v_mov_b32 v88, 0
    v_mov_b32 v89, 0
    v_mov_b32 v90, 0
    v_mov_b32 v91, 0
    v_mov_b32 v125, s56
    s_mov_b32 s59, 0
Lw9:
    ds_read_b32 v124, v125 offset:52
    s_waitcnt lgkmcnt(0)
    v_readfirstlane_b32 s58, v124
    s_nop 3
    s_cmp_ge_u32 s58, 4
    s_cbranch_scc1 Le10
    s_add_u32 s59, s59, 1
    s_cmp_gt_u32 s59, 2097152
    s_cbranch_scc1 Le10
    s_sleep 1
    s_branch Lw9
Le10:
    s_xor_b32 s57, s56, 4
    v_mov_b32 v125, s57
    s_mov_b32 s59, 0
Lw11:
    ds_read_b32 v124, v125 offset:52
    s_waitcnt lgkmcnt(0)
    v_readfirstlane_b32 s58, v124
    s_nop 3
    s_cmp_ge_u32 s58, 4
    s_cbranch_scc1 Le12
    s_add_u32 s59, s59, 1
    s_cmp_gt_u32 s59, 2097152
    s_cbranch_scc1 Le12
    s_sleep 1
    s_branch Lw11
Le12:
    s_mov_b32 s59, 0
Lw13:
    ds_read_b32 v124, v127 offset:28
    s_waitcnt lgkmcnt(0)
    v_readfirstlane_b32 s58, v124
    s_nop 3
    s_cmp_ge_u32 s58, 4
    s_cbranch_scc1 Le14
    s_add_u32 s59, s59, 1
    s_cmp_gt_u32 s59, 2097152
    s_cbranch_scc1 Le14
    s_sleep 1
    s_branch Lw13
Le14:
    s_setprio 2
    ds_read_b128 v[28:31], v9 offset:0
    ds_read2_b32 v[92:93], v7 offset0:128 offset1:129
    ds_read2_b32 v[94:95], v7 offset0:130 offset1:131
    ds_read_b128 v[32:35], v9 offset:512
    ds_read2_b32 v[96:97], v7 offset0:0 offset1:1
    ds_read2_b32 v[98:99], v7 offset0:2 offset1:3
    ds_read_b128 v[36:39], v9 offset:1024
    ds_read2_b32 v[100:101], v6 offset0:128 offset1:129
    ds_read2_b32 v[102:103], v6 offset0:130 offset1:131
    ds_read_b128 v[40:43], v9 offset:1536
    ds_read2_b32 v[104:105], v6 offset0:0 offset1:1
    ds_read2_b32 v[106:107], v6 offset0:2 offset1:3
    s_waitcnt lgkmcnt(9)
    v_mfma_f32_16x16x32_bf16 v[60:63], v[92:95], v[28:31], v[60:63]
    ds_read_b128 v[44:47], v9 offset:2048
    s_waitcnt lgkmcnt(7)
    v_mfma_f32_16x16x32_bf16 v[64:67], v[96:99], v[28:31], v[64:67]
    ds_read2_b32 v[108:109], v5 offset0:128 offset1:129
    v_mfma_f32_16x16x32_bf16 v[68:71], v[96:99], v[32:35], v[68:71]
    ds_read2_b32 v[110:111], v5 offset0:130 offset1:131
    v_mfma_f32_16x16x32_bf16 v[64:67], v[92:95], v[32:35], v[64:67]
    ds_read_b128 v[48:51], v9 offset:2560
    s_waitcnt lgkmcnt(7)
    v_mfma_f32_16x16x32_bf16 v[68:71], v[100:103], v[28:31], v[68:71]
    ds_read2_b32 v[112:113], v5 offset0:0 offset1:1
    v_mfma_f32_16x16x32_bf16 v[72:75], v[100:103], v[32:35], v[72:75]
    ds_read2_b32 v[114:115], v5 offset0:2 offset1:3
    v_mfma_f32_16x16x32_bf16 v[76:79], v[100:103], v[36:39], v[76:79]
    ds_read_b128 v[52:55], v9 offset:3072
    v_mfma_f32_16x16x32_bf16 v[68:71], v[92:95], v[36:39], v[68:71]
    ds_read2_b32 v[116:117], v4 offset0:128 offset1:129
    v_mfma_f32_16x16x32_bf16 v[72:75], v[96:99], v[36:39], v[72:75]
    ds_read2_b32 v[118:119], v4 offset0:130 offset1:131
    s_waitcnt lgkmcnt(9)
    v_mfma_f32_16x16x32_bf16 v[72:75], v[104:107], v[28:31], v[72:75]
    ds_read_b128 v[56:59], v9 offset:3584
    v_mfma_f32_16x16x32_bf16 v[76:79], v[104:107], v[32:35], v[76:79]
    ds_read2_b32 v[120:121], v4 offset0:0 offset1:1
    v_mfma_f32_16x16x32_bf16 v[80:83], v[104:107], v[36:39], v[80:83]
    ds_read2_b32 v[122:123], v4 offset0:2 offset1:3
    v_mfma_f32_16x16x32_bf16 v[84:87], v[104:107], v[40:43], v[84:87]
    v_mfma_f32_16x16x32_bf16 v[72:75], v[92:95], v[40:43], v[72:75]
    v_mfma_f32_16x16x32_bf16 v[76:79], v[96:99], v[40:43], v[76:79]
    v_mfma_f32_16x16x32_bf16 v[80:83], v[100:103], v[40:43], v[80:83]
    s_waitcnt lgkmcnt(9)
    v_mfma_f32_16x16x32_bf16 v[76:79], v[108:111], v[28:31], v[76:79]
    v_mfma_f32_16x16x32_bf16 v[80:83], v[108:111], v[32:35], v[80:83]
    v_mfma_f32_16x16x32_bf16 v[84:87], v[108:111], v[36:39], v[84:87]
    v_mfma_f32_16x16x32_bf16 v[88:91], v[108:111], v[40:43], v[88:91]
    v_mfma_f32_16x16x32_bf16 v[76:79], v[92:95], v[44:47], v[76:79]
    v_mfma_f32_16x16x32_bf16 v[80:83], v[96:99], v[44:47], v[80:83]
    v_mfma_f32_16x16x32_bf16 v[84:87], v[100:103], v[44:47], v[84:87]
    v_mfma_f32_16x16x32_bf16 v[88:91], v[104:107], v[44:47], v[88:91]
    v_subrev_u32 v4, 64, v4
    v_subrev_u32 v5, 64, v5
    v_subrev_u32 v6, 64, v6
    v_subrev_u32 v7, 64, v7
    v_subrev_u32 v9, 64, v9
    s_waitcnt lgkmcnt(6)
    v_mfma_f32_16x16x32_bf16 v[80:83], v[112:115], v[28:31], v[80:83]
    ds_read_b128 v[44:47], v9 offset:0
    v_mfma_f32_16x16x32_bf16 v[84:87], v[112:115], v[32:35], v[84:87]
    ds_read2_b32 v[108:109], v7 offset0:128 offset1:129
    v_mfma_f32_16x16x32_bf16 v[88:91], v[112:115], v[36:39], v[88:91]
    ds_read2_b32 v[110:111], v7 offset0:130 offset1:131
    v_mfma_f32_16x16x32_bf16 v[80:83], v[92:95], v[48:51], v[80:83]
    ds_read_b128 v[40:43], v9 offset:512
    v_mfma_f32_16x16x32_bf16 v[84:87], v[96:99], v[48:51], v[84:87]
    ds_read2_b32 v[104:105], v7 offset0:0 offset1:1
    v_mfma_f32_16x16x32_bf16 v[88:91], v[100:103], v[48:51], v[88:91]
    ds_read2_b32 v[106:107], v7 offset0:2 offset1:3
    s_waitcnt lgkmcnt(9)
    v_mfma_f32_16x16x32_bf16 v[84:87], v[116:119], v[28:31], v[84:87]
    ds_read_b128 v[48:51], v9 offset:1024
    v_mfma_f32_16x16x32_bf16 v[88:91], v[116:119], v[32:35], v[88:91]
    ds_read2_b32 v[112:113], v6 offset0:128 offset1:129
    v_mfma_f32_16x16x32_bf16 v[84:87], v[92:95], v[52:55], v[84:87]
    ds_read2_b32 v[114:115], v6 offset0:130 offset1:131
    v_mfma_f32_16x16x32_bf16 v[88:91], v[96:99], v[52:55], v[88:91]
    ds_read_b128 v[36:39], v9 offset:1536
    s_waitcnt lgkmcnt(10)
    v_mfma_f32_16x16x32_bf16 v[88:91], v[120:123], v[28:31], v[88:91]
    ds_read2_b32 v[100:101], v6 offset0:0 offset1:1
    v_mfma_f32_16x16x32_bf16 v[88:91], v[92:95], v[56:59], v[88:91]
    ds_read2_b32 v[102:103], v6 offset0:2 offset1:3
    s_waitcnt lgkmcnt(9)
    v_mfma_f32_16x16x32_bf16 v[60:63], v[108:111], v[44:47], v[60:63]
    ds_read_b128 v[52:55], v9 offset:2048
    s_waitcnt lgkmcnt(7)
    v_mfma_f32_16x16x32_bf16 v[64:67], v[104:107], v[44:47], v[64:67]
    ds_read2_b32 v[116:117], v5 offset0:128 offset1:129
    v_mfma_f32_16x16x32_bf16 v[68:71], v[104:107], v[40:43], v[68:71]
    ds_read2_b32 v[118:119], v5 offset0:130 offset1:131
    v_mfma_f32_16x16x32_bf16 v[64:67], v[108:111], v[40:43], v[64:67]
    ds_read_b128 v[32:35], v9 offset:2560
    s_waitcnt lgkmcnt(7)
    v_mfma_f32_16x16x32_bf16 v[68:71], v[112:115], v[44:47], v[68:71]
    ds_read2_b32 v[96:97], v5 offset0:0 offset1:1
    v_mfma_f32_16x16x32_bf16 v[72:75], v[112:115], v[40:43], v[72:75]
    ds_read2_b32 v[98:99], v5 offset0:2 offset1:3
    v_mfma_f32_16x16x32_bf16 v[76:79], v[112:115], v[48:51], v[76:79]
    ds_read_b128 v[56:59], v9 offset:3072
    v_mfma_f32_16x16x32_bf16 v[68:71], v[108:111], v[48:51], v[68:71]
    ds_read2_b32 v[120:121], v4 offset0:128 offset1:129
    v_mfma_f32_16x16x32_bf16 v[72:75], v[104:107], v[48:51], v[72:75]
    ds_read2_b32 v[122:123], v4 offset0:130 offset1:131
    s_waitcnt lgkmcnt(9)
    v_mfma_f32_16x16x32_bf16 v[72:75], v[100:103], v[44:47], v[72:75]
    ds_read_b128 v[28:31], v9 offset:3584
    v_mfma_f32_16x16x32_bf16 v[76:79], v[100:103], v[40:43], v[76:79]
    ds_read2_b32 v[92:93], v4 offset0:0 offset1:1
    v_mfma_f32_16x16x32_bf16 v[80:83], v[100:103], v[48:51], v[80:83]
    ds_read2_b32 v[94:95], v4 offset0:2 offset1:3
    v_mfma_f32_16x16x32_bf16 v[84:87], v[100:103], v[36:39], v[84:87]
    v_mfma_f32_16x16x32_bf16 v[72:75], v[108:111], v[36:39], v[72:75]
    v_mfma_f32_16x16x32_bf16 v[76:79], v[104:107], v[36:39], v[76:79]
    v_mfma_f32_16x16x32_bf16 v[80:83], v[112:115], v[36:39], v[80:83]
    s_waitcnt lgkmcnt(9)
    v_mfma_f32_16x16x32_bf16 v[76:79], v[116:119], v[44:47], v[76:79]
    v_mfma_f32_16x16x32_bf16 v[80:83], v[116:119], v[40:43], v[80:83]
    v_mfma_f32_16x16x32_bf16 v[84:87], v[116:119], v[48:51], v[84:87]
    v_mfma_f32_16x16x32_bf16 v[88:91], v[116:119], v[36:39], v[88:91]
    v_mfma_f32_16x16x32_bf16 v[76:79], v[108:111], v[52:55], v[76:79]
    v_mfma_f32_16x16x32_bf16 v[80:83], v[104:107], v[52:55], v[80:83]
    v_mfma_f32_16x16x32_bf16 v[84:87], v[112:115], v[52:55], v[84:87]
    v_mfma_f32_16x16x32_bf16 v[88:91], v[100:103], v[52:55], v[88:91]
    v_subrev_u32 v4, 64, v4
    v_subrev_u32 v5, 64, v5
    v_subrev_u32 v6, 64, v6
    v_subrev_u32 v7, 64, v7
    v_subrev_u32 v9, 64, v9
    s_waitcnt lgkmcnt(6)
    v_mfma_f32_16x16x32_bf16 v[80:83], v[96:99], v[44:47], v[80:83]
    ds_read_b128 v[52:55], v9 offset:0
    v_mfma_f32_16x16x32_bf16 v[84:87], v[96:99], v[40:43], v[84:87]
    ds_read2_b32 v[116:117], v7 offset0:128 offset1:129
    v_mfma_f32_16x16x32_bf16 v[88:91], v[96:99], v[48:51], v[88:91]
    ds_read2_b32 v[118:119], v7 offset0:130 offset1:131
    v_mfma_f32_16x16x32_bf16 v[80:83], v[108:111], v[32:35], v[80:83]
    ds_read_b128 v[36:39], v9 offset:512
    v_mfma_f32_16x16x32_bf16 v[84:87], v[104:107], v[32:35], v[84:87]
    ds_read2_b32 v[100:101], v7 offset0:0 offset1:1
    v_mfma_f32_16x16x32_bf16 v[88:91], v[112:115], v[32:35], v[88:91]
    ds_read2_b32 v[102:103], v7 offset0:2 offset1:3
    s_waitcnt lgkmcnt(9)
    v_mfma_f32_16x16x32_bf16 v[84:87], v[120:123], v[44:47], v[84:87]
    ds_read_b128 v[32:35], v9 offset:1024
    v_mfma_f32_16x16x32_bf16 v[88:91], v[120:123], v[40:43], v[88:91]
    ds_read2_b32 v[96:97], v6 offset0:128 offset1:129
    v_mfma_f32_16x16x32_bf16 v[84:87], v[108:111], v[56:59], v[84:87]
    ds_read2_b32 v[98:99], v6 offset0:130 offset1:131
    v_mfma_f32_16x16x32_bf16 v[88:91], v[104:107], v[56:59], v[88:91]
    ds_read_b128 v[48:51], v9 offset:1536
    s_waitcnt lgkmcnt(10)
    v_mfma_f32_16x16x32_bf16 v[88:91], v[92:95], v[44:47], v[88:91]
    ds_read2_b32 v[112:113], v6 offset0:0 offset1:1
    v_mfma_f32_16x16x32_bf16 v[88:91], v[108:111], v[28:31], v[88:91]
    ds_read2_b32 v[114:115], v6 offset0:2 offset1:3
    s_waitcnt lgkmcnt(9)
    v_mfma_f32_16x16x32_bf16 v[60:63], v[116:119], v[52:55], v[60:63]
    ds_read_b128 v[56:59], v9 offset:2048
    s_waitcnt lgkmcnt(7)
    v_mfma_f32_16x16x32_bf16 v[64:67], v[100:103], v[52:55], v[64:67]
    ds_read2_b32 v[120:121], v5 offset0:128 offset1:129
    v_mfma_f32_16x16x32_bf16 v[68:71], v[100:103], v[36:39], v[68:71]
    ds_read2_b32 v[122:123], v5 offset0:130 offset1:131
    v_mfma_f32_16x16x32_bf16 v[64:67], v[116:119], v[36:39], v[64:67]
    ds_read_b128 v[40:43], v9 offset:2560
    s_waitcnt lgkmcnt(7)
    v_mfma_f32_16x16x32_bf16 v[68:71], v[96:99], v[52:55], v[68:71]
    ds_read2_b32 v[104:105], v5 offset0:0 offset1:1
    v_mfma_f32_16x16x32_bf16 v[72:75], v[96:99], v[36:39], v[72:75]
    ds_read2_b32 v[106:107], v5 offset0:2 offset1:3
    v_mfma_f32_16x16x32_bf16 v[76:79], v[96:99], v[32:35], v[76:79]
    ds_read_b128 v[28:31], v9 offset:3072
    v_mfma_f32_16x16x32_bf16 v[68:71], v[116:119], v[32:35], v[68:71]
    ds_read2_b32 v[92:93], v4 offset0:128 offset1:129
    v_mfma_f32_16x16x32_bf16 v[72:75], v[100:103], v[32:35], v[72:75]
    ds_read2_b32 v[94:95], v4 offset0:130 offset1:131
    s_waitcnt lgkmcnt(9)
    v_mfma_f32_16x16x32_bf16 v[72:75], v[112:115], v[52:55], v[72:75]
    ds_read_b128 v[44:47], v9 offset:3584
    v_mfma_f32_16x16x32_bf16 v[76:79], v[112:115], v[36:39], v[76:79]
    ds_read2_b32 v[108:109], v4 offset0:0 offset1:1
    v_mfma_f32_16x16x32_bf16 v[80:83], v[112:115], v[32:35], v[80:83]
    ds_read2_b32 v[110:111], v4 offset0:2 offset1:3
    v_mfma_f32_16x16x32_bf16 v[84:87], v[112:115], v[48:51], v[84:87]
    v_mfma_f32_16x16x32_bf16 v[72:75], v[116:119], v[48:51], v[72:75]
    v_mfma_f32_16x16x32_bf16 v[76:79], v[100:103], v[48:51], v[76:79]
    v_mfma_f32_16x16x32_bf16 v[80:83], v[96:99], v[48:51], v[80:83]
    s_waitcnt lgkmcnt(9)
    v_mfma_f32_16x16x32_bf16 v[76:79], v[120:123], v[52:55], v[76:79]
    v_mfma_f32_16x16x32_bf16 v[80:83], v[120:123], v[36:39], v[80:83]
    v_mfma_f32_16x16x32_bf16 v[84:87], v[120:123], v[32:35], v[84:87]
    v_mfma_f32_16x16x32_bf16 v[88:91], v[120:123], v[48:51], v[88:91]
    v_mfma_f32_16x16x32_bf16 v[76:79], v[116:119], v[56:59], v[76:79]
    v_mfma_f32_16x16x32_bf16 v[80:83], v[100:103], v[56:59], v[80:83]
    v_mfma_f32_16x16x32_bf16 v[84:87], v[96:99], v[56:59], v[84:87]
    v_mfma_f32_16x16x32_bf16 v[88:91], v[112:115], v[56:59], v[88:91]
    v_subrev_u32 v4, 64, v4
    v_subrev_u32 v5, 64, v5
    v_subrev_u32 v6, 64, v6
    v_subrev_u32 v7, 64, v7
    v_subrev_u32 v9, 64, v9
    s_waitcnt lgkmcnt(6)
    v_mfma_f32_16x16x32_bf16 v[80:83], v[104:107], v[52:55], v[80:83]
    ds_read_b128 v[56:59], v9 offset:0
    v_mfma_f32_16x16x32_bf16 v[84:87], v[104:107], v[36:39], v[84:87]
    ds_read2_b32 v[120:121], v7 offset0:128 offset1:129
    v_mfma_f32_16x16x32_bf16 v[88:91], v[104:107], v[32:35], v[88:91]
    ds_read2_b32 v[122:123], v7 offset0:130 offset1:131
    v_mfma_f32_16x16x32_bf16 v[80:83], v[116:119], v[40:43], v[80:83]
    ds_read_b128 v[48:51], v9 offset:512
    v_mfma_f32_16x16x32_bf16 v[84:87], v[100:103], v[40:43], v[84:87]
    ds_read2_b32 v[112:113], v7 offset0:0 offset1:1
    v_mfma_f32_16x16x32_bf16 v[88:91], v[96:99], v[40:43], v[88:91]
    ds_read2_b32 v[114:115], v7 offset0:2 offset1:3
    s_waitcnt lgkmcnt(9)
    v_mfma_f32_16x16x32_bf16 v[84:87], v[92:95], v[52:55], v[84:87]
    ds_read_b128 v[40:43], v9 offset:1024
    v_mfma_f32_16x16x32_bf16 v[88:91], v[92:95], v[36:39], v[88:91]
    ds_read2_b32 v[104:105], v6 offset0:128 offset1:129
    v_mfma_f32_16x16x32_bf16 v[84:87], v[116:119], v[28:31], v[84:87]
    ds_read2_b32 v[106:107], v6 offset0:130 offset1:131
    v_mfma_f32_16x16x32_bf16 v[88:91], v[100:103], v[28:31], v[88:91]
    ds_read_b128 v[32:35], v9 offset:1536
    s_waitcnt lgkmcnt(10)
    v_mfma_f32_16x16x32_bf16 v[88:91], v[108:111], v[52:55], v[88:91]
    ds_read2_b32 v[96:97], v6 offset0:0 offset1:1
    v_mfma_f32_16x16x32_bf16 v[88:91], v[116:119], v[44:47], v[88:91]
    ds_read2_b32 v[98:99], v6 offset0:2 offset1:3
    s_waitcnt lgkmcnt(9)
    v_mfma_f32_16x16x32_bf16 v[60:63], v[120:123], v[56:59], v[60:63]
    ds_read_b128 v[28:31], v9 offset:2048
    s_waitcnt lgkmcnt(7)
    v_mfma_f32_16x16x32_bf16 v[64:67], v[112:115], v[56:59], v[64:67]
    ds_read2_b32 v[92:93], v5 offset0:128 offset1:129
    v_mfma_f32_16x16x32_bf16 v[68:71], v[112:115], v[48:51], v[68:71]
    ds_read2_b32 v[94:95], v5 offset0:130 offset1:131
    v_mfma_f32_16x16x32_bf16 v[64:67], v[120:123], v[48:51], v[64:67]
    ds_read_b128 v[36:39], v9 offset:2560
    s_waitcnt lgkmcnt(7)
    v_mfma_f32_16x16x32_bf16 v[68:71], v[104:107], v[56:59], v[68:71]
    ds_read2_b32 v[100:101], v5 offset0:0 offset1:1
    v_mfma_f32_16x16x32_bf16 v[72:75], v[104:107], v[48:51], v[72:75]
    ds_read2_b32 v[102:103], v5 offset0:2 offset1:3
    v_mfma_f32_16x16x32_bf16 v[76:79], v[104:107], v[40:43], v[76:79]
    ds_read_b128 v[44:47], v9 offset:3072
    v_mfma_f32_16x16x32_bf16 v[68:71], v[120:123], v[40:43], v[68:71]
    ds_read2_b32 v[108:109], v4 offset0:128 offset1:129
    v_mfma_f32_16x16x32_bf16 v[72:75], v[112:115], v[40:43], v[72:75]
    ds_read2_b32 v[110:111], v4 offset0:130 offset1:131
    s_waitcnt lgkmcnt(9)
    v_mfma_f32_16x16x32_bf16 v[72:75], v[96:99], v[56:59], v[72:75]
    ds_read_b128 v[52:55], v9 offset:3584
    v_mfma_f32_16x16x32_bf16 v[76:79], v[96:99], v[48:51], v[76:79]
    ds_read2_b32 v[116:117], v4 offset0:0 offset1:1
    v_mfma_f32_16x16x32_bf16 v[80:83], v[96:99], v[40:43], v[80:83]
    ds_read2_b32 v[118:119], v4 offset0:2 offset1:3
    v_mfma_f32_16x16x32_bf16 v[84:87], v[96:99], v[32:35], v[84:87]
    v_mfma_f32_16x16x32_bf16 v[72:75], v[120:123], v[32:35], v[72:75]
    v_mfma_f32_16x16x32_bf16 v[76:79], v[112:115], v[32:35], v[76:79]
    v_mfma_f32_16x16x32_bf16 v[80:83], v[104:107], v[32:35], v[80:83]
    s_waitcnt lgkmcnt(9)
    v_mfma_f32_16x16x32_bf16 v[76:79], v[92:95], v[56:59], v[76:79]
    v_mfma_f32_16x16x32_bf16 v[80:83], v[92:95], v[48:51], v[80:83]
    v_mfma_f32_16x16x32_bf16 v[84:87], v[92:95], v[40:43], v[84:87]
    v_mfma_f32_16x16x32_bf16 v[88:91], v[92:95], v[32:35], v[88:91]
    v_mfma_f32_16x16x32_bf16 v[76:79], v[120:123], v[28:31], v[76:79]
    v_mfma_f32_16x16x32_bf16 v[80:83], v[112:115], v[28:31], v[80:83]
    v_mfma_f32_16x16x32_bf16 v[84:87], v[104:107], v[28:31], v[84:87]
    v_mfma_f32_16x16x32_bf16 v[88:91], v[96:99], v[28:31], v[88:91]
    s_waitcnt lgkmcnt(6)
    v_mfma_f32_16x16x32_bf16 v[80:83], v[100:103], v[56:59], v[80:83]
    v_mfma_f32_16x16x32_bf16 v[84:87], v[100:103], v[48:51], v[84:87]
    v_mfma_f32_16x16x32_bf16 v[88:91], v[100:103], v[40:43], v[88:91]
    v_mfma_f32_16x16x32_bf16 v[80:83], v[120:123], v[36:39], v[80:83]
    v_mfma_f32_16x16x32_bf16 v[84:87], v[112:115], v[36:39], v[84:87]
    v_mfma_f32_16x16x32_bf16 v[88:91], v[104:107], v[36:39], v[88:91]
    s_waitcnt lgkmcnt(3)
    v_mfma_f32_16x16x32_bf16 v[84:87], v[108:111], v[56:59], v[84:87]
    v_mfma_f32_16x16x32_bf16 v[88:91], v[108:111], v[48:51], v[88:91]
    v_mfma_f32_16x16x32_bf16 v[84:87], v[120:123], v[44:47], v[84:87]
    v_mfma_f32_16x16x32_bf16 v[88:91], v[112:115], v[44:47], v[88:91]
    s_waitcnt lgkmcnt(0)
    v_mfma_f32_16x16x32_bf16 v[88:91], v[116:119], v[56:59], v[88:91]
    v_mfma_f32_16x16x32_bf16 v[88:91], v[120:123], v[52:55], v[88:91]
    s_lshl_b32 s31, s4, 1
    s_add_u32 s31, s31, s6
    s_lshl_b32 s33, s31, 12
    s_add_u32 s33, s33, 256
    v_add_u32 v2, s33, v1
    s_xor_b32 s33, s31, 1
    s_lshl_b32 s33, s33, 12
    s_add_u32 s33, s33, 256
    v_add_u32 v3, s33, v1
    s_cmp_eq_u32 s6, 0
    s_cbranch_scc0 gated_mix__ssm_conv_s4__spectral_gfnet__prompt_kernel_cx1
    ds_write_b128 v2, v[76:79] offset:0
    ds_write_b128 v2, v[80:83] offset:1024
    ds_write_b128 v2, v[84:87] offset:2048
    ds_write_b128 v2, v[88:91] offset:3072
    s_branch gated_mix__ssm_conv_s4__spectral_gfnet__prompt_kernel_cx2
gated_mix__ssm_conv_s4__spectral_gfnet__prompt_kernel_cx1:
    ds_write_b128 v2, v[60:63] offset:0
    ds_write_b128 v2, v[64:67] offset:1024
    ds_write_b128 v2, v[68:71] offset:2048
    ds_write_b128 v2, v[72:75] offset:3072
    s_waitcnt lgkmcnt(0)
    v_mov_b32 v60, v76
    v_mov_b32 v61, v77
    v_mov_b32 v62, v78
    v_mov_b32 v63, v79
    v_mov_b32 v64, v80
    v_mov_b32 v65, v81
    v_mov_b32 v66, v82
    v_mov_b32 v67, v83
    v_mov_b32 v68, v84
    v_mov_b32 v69, v85
    v_mov_b32 v70, v86
    v_mov_b32 v71, v87
    v_mov_b32 v72, v88
    v_mov_b32 v73, v89
    v_mov_b32 v74, v90
    v_mov_b32 v75, v91
gated_mix__ssm_conv_s4__spectral_gfnet__prompt_kernel_cx2:
    v_lshlrev_b32 v16, 5, v10
    v_lshl_add_u32 v16, v11, 3, v16
    s_lshl_b32 s34, s6, 11
    s_sub_u32 s36, s7, s34
    s_add_u32 s36, s36, 2552
    v_sub_u32 v17, s36, v16
    v_and_b32 v18, 1, v11
    v_mul_u32_u24 v18, 504, v18
    v_add_u32 v18, v18, v16
    s_lshl_b32 s36, s5, 12
    s_add_u32 s36, s36, s34
    s_add_u32 s36, s36, 13631488
    v_add_u32 v18, s36, v18
    s_waitcnt lgkmcnt(0)
    v_mov_b32 v125, s56
    s_mov_b64 exec, 1
    ds_add_u32 v125, v126 offset:60
    s_mov_b64 exec, -1
    v_mov_b32 v125, s56
    s_mov_b32 s59, 0
Lw15:
    ds_read_b32 v124, v125 offset:60
    s_waitcnt lgkmcnt(0)
    v_readfirstlane_b32 s58, v124
    s_nop 3
    s_cmp_ge_u32 s58, 2
    s_cbranch_scc1 Le16
    s_add_u32 s59, s59, 1
    s_cmp_gt_u32 s59, 2097152
    s_cbranch_scc1 Le16
    s_sleep 1
    s_branch Lw15
Le16:
    s_mov_b32 s59, 0
Lw17:
    ds_read_b32 v124, v127 offset:100
    s_waitcnt lgkmcnt(0)
    v_readfirstlane_b32 s58, v124
    s_nop 3
    s_cmp_ge_u32 s58, 2
    s_cbranch_scc1 Le18
    s_add_u32 s59, s59, 1
    s_cmp_gt_u32 s59, 2097152
    s_cbranch_scc1 Le18
    s_sleep 1
    s_branch Lw17
Le18:
    ds_read_b128 v[28:31], v3 offset:0
    ds_read_b64 v[44:45], v17 offset:1536
    ds_read_b128 v[32:35], v3 offset:1024
    ds_read_b64 v[46:47], v17 offset:1024
    ds_read_b128 v[36:39], v3 offset:2048
    ds_read_b64 v[48:49], v17 offset:512
    ds_read_b128 v[40:43], v3 offset:3072
    ds_read_b64 v[50:51], v17 offset:0
    s_waitcnt lgkmcnt(6)
    v_pk_add_f32 v[60:61], v[60:61], v[28:29]
    v_pk_add_f32 v[62:63], v[62:63], v[30:31]
    v_and_b32 v20, 0xffff0000, v45
    v_lshlrev_b32 v21, 16, v45
    v_and_b32 v22, 0xffff0000, v44
    v_lshlrev_b32 v23, 16, v44
    v_fmac_f32 v60, s55, v20
    v_fmac_f32 v61, s55, v21
    v_fmac_f32 v62, s55, v22
    v_fmac_f32 v63, s55, v23
    v_cvt_pk_bf16_f32 v52, v60, v61
    v_cvt_pk_bf16_f32 v53, v62, v63
    s_waitcnt lgkmcnt(4)
    v_pk_add_f32 v[64:65], v[64:65], v[32:33]
    v_pk_add_f32 v[66:67], v[66:67], v[34:35]
    v_and_b32 v20, 0xffff0000, v47
    v_lshlrev_b32 v21, 16, v47
    v_and_b32 v22, 0xffff0000, v46
    v_lshlrev_b32 v23, 16, v46
    v_fmac_f32 v64, s55, v20
    v_fmac_f32 v65, s55, v21
    v_fmac_f32 v66, s55, v22
    v_fmac_f32 v67, s55, v23
    v_cvt_pk_bf16_f32 v54, v64, v65
    v_cvt_pk_bf16_f32 v55, v66, v67
    s_nop 0
    v_permlane16_swap_b32 v52, v54
    v_permlane16_swap_b32 v53, v55
    global_store_dwordx4 v18, v[52:55], s[24:25] offset:0 sc1
    s_waitcnt lgkmcnt(2)
    v_pk_add_f32 v[68:69], v[68:69], v[36:37]
    v_pk_add_f32 v[70:71], v[70:71], v[38:39]
    v_and_b32 v20, 0xffff0000, v49
    v_lshlrev_b32 v21, 16, v49
    v_and_b32 v22, 0xffff0000, v48
    v_lshlrev_b32 v23, 16, v48
    v_fmac_f32 v68, s55, v20
    v_fmac_f32 v69, s55, v21
    v_fmac_f32 v70, s55, v22
    v_fmac_f32 v71, s55, v23
    v_cvt_pk_bf16_f32 v56, v68, v69
    v_cvt_pk_bf16_f32 v57, v70, v71
    s_waitcnt lgkmcnt(0)
    v_pk_add_f32 v[72:73], v[72:73], v[40:41]
    v_pk_add_f32 v[74:75], v[74:75], v[42:43]
    v_and_b32 v20, 0xffff0000, v51
    v_lshlrev_b32 v21, 16, v51
    v_and_b32 v22, 0xffff0000, v50
    v_lshlrev_b32 v23, 16, v50
    v_fmac_f32 v72, s55, v20
    v_fmac_f32 v73, s55, v21
    v_fmac_f32 v74, s55, v22
    v_fmac_f32 v75, s55, v23
    v_cvt_pk_bf16_f32 v58, v72, v73
    v_cvt_pk_bf16_f32 v59, v74, v75
    s_nop 0
    v_permlane16_swap_b32 v56, v58
    v_permlane16_swap_b32 v57, v59
    global_store_dwordx4 v18, v[56:59], s[24:25] offset:1024 sc1
    s_mov_b64 exec, 1
    ds_add_u32 v127, v126 offset:108
    s_mov_b64 exec, -1
    s_endpgm
gated_mix__ssm_conv_s4__spectral_gfnet__prompt_kernel_B:
    s_load_dwordx2 s[8:9], s[0:1], 0
    s_load_dwordx2 s[10:11], s[0:1], 96
    s_sub_u32 s4, s3, 8
    s_and_b32 s5, s4, 1
    s_lshl_b32 s6, s2, 1
    s_add_u32 s5, s5, s6
    s_lshr_b32 s6, s4, 1
    s_mul_i32 s7, s4, 5280
    s_add_u32 s7, s7, 49408
    s_mul_i32 s26, s5, 3584
    v_lshl_add_u32 v1, v0, 4, s26
    v_lshlrev_b32 v2, 4, v0
    s_memrealtime s[50:51]
    s_waitcnt lgkmcnt(0)
    s_or_b32 s50, s50, 1
    s_or_b32 s27, s4, s2
    s_cmp_lg_u32 s27, 0
    s_cbranch_scc1 gated_mix__ssm_conv_s4__spectral_gfnet__prompt_kernel_b_np
    v_lshlrev_b32 v3, 6, v0
    v_mov_b32 v4, s50
    s_mov_b64 exec, 15
    global_store_dword v3, v4, s[60:61] sc1
    s_mov_b64 exec, -1
gated_mix__ssm_conv_s4__spectral_gfnet__prompt_kernel_b_np:
    s_mov_b32 s12, s8
    s_and_b32 s13, s9, 0xffff
    s_mov_b32 s14, 1835008
    s_mov_b32 s15, 0x00020000
    s_mov_b32 s16, s10
    s_and_b32 s17, s11, 0xffff
    s_mov_b32 s18, 896
    s_mov_b32 s19, 0x00020000
    s_add_u32 m0, s7, 0
    s_mov_b32 s27, 0
    buffer_load_dwordx4 v1, s[12:15], s27 offen lds
    s_add_u32 m0, s7, 1056
    s_mov_b32 s27, 896
    buffer_load_dwordx4 v1, s[12:15], s27 offen lds
    s_add_u32 m0, s7, 2112
    s_mov_b32 s27, 1792
    buffer_load_dwordx4 v1, s[12:15], s27 offen lds
    s_add_u32 m0, s7, 3168
    s_mov_b32 s27, 2688
    buffer_load_dwordx4 v1, s[12:15], s27 offen lds
    s_add_u32 m0, s7, 4224
    s_nop 0
    buffer_load_dwordx4 v2, s[16:19], 0 offen lds
    s_barrier
    s_setprio 3
    v_and_b32 v3, 15, v0
    s_lshl_b32 s27, s6, 4
    v_add_u32 v3, s27, v3
    v_cvt_f32_u32 v42, v3
    v_mul_f32 v36, 0x3c924925, v42
    v_lshrrev_b32 v43, 4, v0
    v_cvt_f32_u32 v44, v43
    v_mul_f32 v44, 0x41000000, v44
    v_mul_f32 v37, v36, v44
    v_fmamk_f32 v38, v36, 0x00000000, v37
    v_fmamk_f32 v39, v36, 0x3f800000, v37
    v_cos_f32 v40, v38
    v_cos_f32 v41, v39
    v_sin_f32 v38, v38
    v_sin_f32 v39, v39
    v_cvt_pk_bf16_f32 v4, v40, v41
    v_cvt_pk_bf16_f32 v12, -v38, -v39
    v_fmamk_f32 v38, v36, 0x40000000, v37
    v_fmamk_f32 v39, v36, 0x40400000, v37
    v_cos_f32 v40, v38
    v_cos_f32 v41, v39
    v_sin_f32 v38, v38
    v_sin_f32 v39, v39
    v_cvt_pk_bf16_f32 v5, v40, v41
    v_cvt_pk_bf16_f32 v13, -v38, -v39
    v_fmamk_f32 v38, v36, 0x40800000, v37
    v_fmamk_f32 v39, v36, 0x40a00000, v37
    v_cos_f32 v40, v38
    v_cos_f32 v41, v39
    v_sin_f32 v38, v38
    v_sin_f32 v39, v39
    v_cvt_pk_bf16_f32 v6, v40, v41
    v_cvt_pk_bf16_f32 v14, -v38, -v39
    v_fmamk_f32 v38, v36, 0x40c00000, v37
    v_fmamk_f32 v39, v36, 0x40e00000, v37
    v_cos_f32 v40, v38
    v_cos_f32 v41, v39
    v_sin_f32 v38, v38
    v_sin_f32 v39, v39
    v_cvt_pk_bf16_f32 v7, v40, v41
    v_cvt_pk_bf16_f32 v15, -v38, -v39
    v_fmamk_f32 v38, v36, 0x42000000, v37
    v_fmamk_f32 v39, v36, 0x42040000, v37
    v_cos_f32 v40, v38
    v_cos_f32 v41, v39
    v_sin_f32 v38, v38
    v_sin_f32 v39, v39
    v_cvt_pk_bf16_f32 v8, v40, v41
    v_cvt_pk_bf16_f32 v16, -v38, -v39
    v_fmamk_f32 v38, v36, 0x42080000, v37
    v_fmamk_f32 v39, v36, 0x420c0000, v37
    v_cos_f32 v40, v38
    v_cos_f32 v41, v39
    v_sin_f32 v38, v38
    v_sin_f32 v39, v39
    v_cvt_pk_bf16_f32 v9, v40, v41
    v_cvt_pk_bf16_f32 v17, -v38, -v39
    v_fmamk_f32 v38, v36, 0x42100000, v37
    v_fmamk_f32 v39, v36, 0x42140000, v37
    v_cos_f32 v40, v38
    v_cos_f32 v41, v39
    v_sin_f32 v38, v38
    v_sin_f32 v39, v39
    v_cvt_pk_bf16_f32 v10, v40, v41
    v_cvt_pk_bf16_f32 v18, -v38, -v39
    v_fmamk_f32 v38, v36, 0x42180000, v37
    v_fmamk_f32 v39, v36, 0x421c0000, v37
    v_cos_f32 v40, v38
    v_cos_f32 v41, v39
    v_sin_f32 v38, v38
    v_sin_f32 v39, v39
    v_cvt_pk_bf16_f32 v11, v40, v41
    v_cvt_pk_bf16_f32 v19, -v38, -v39
    v_cmp_ne_u32 vcc, 3, v43
    s_nop 1
    v_cndmask_b32 v8, 0, v8, vcc
    v_cndmask_b32 v16, 0, v16, vcc
    v_cndmask_b32 v9, 0, v9, vcc
    v_cndmask_b32 v17, 0, v17, vcc
    v_cndmask_b32 v10, 0, v10, vcc
    v_cndmask_b32 v18, 0, v18, vcc
    v_cndmask_b32 v11, 0, v11, vcc
    v_cndmask_b32 v19, 0, v19, vcc
    v_mul_f32 v36, 0xbb124925, v42
    v_mov_b32 v20, 1.0
    v_mov_b32 v28, 0
    v_mul_f32 v38, 0x3f800000, v36
    v_cos_f32 v21, v38
    v_sin_f32 v29, v38
    v_mul_f32 v38, 0x40000000, v36
    v_cos_f32 v22, v38
    v_sin_f32 v30, v38
    v_mul_f32 v38, 0x40400000, v36
    v_cos_f32 v23, v38
    v_sin_f32 v31, v38
    v_mul_f32 v38, 0x40800000, v36
    v_cos_f32 v24, v38
    v_sin_f32 v32, v38
    v_mul_f32 v38, 0x40a00000, v36
    v_cos_f32 v25, v38
    v_sin_f32 v33, v38
    v_mul_f32 v38, 0x40c00000, v36
    v_cos_f32 v26, v38
    v_sin_f32 v34, v38
    v_mul_f32 v38, 0x40e00000, v36
    v_cos_f32 v27, v38
    v_sin_f32 v35, v38
    v_and_b32 v47, 3, v0
    v_bfe_u32 v48, v0, 2, 2
    v_lshlrev_b32 v49, 7, v43
    v_lshl_add_u32 v49, v48, 4, v49
    v_add_u32 v49, s7, v49
    v_mul_u32_u24 v50, 1056, v47
    v_add_u32 v45, v49, v50
    v_and_b32 v50, 1, v47
    v_lshl_add_u32 v46, v50, 3, v49
    s_waitcnt vmcnt(0)
    ds_read_b64_tr_b16 v[48:49], v45 offset:0
    ds_read_b64_tr_b16 v[50:51], v45 offset:64
    ds_read_b64_tr_b16 v[52:53], v45 offset:512
    ds_read_b64_tr_b16 v[54:55], v45 offset:576
    ds_read_b64_tr_b16 v[56:57], v45 offset:8
    ds_read_b64_tr_b16 v[58:59], v45 offset:72
    ds_read_b64_tr_b16 v[60:61], v45 offset:520
    ds_read_b64_tr_b16 v[62:63], v45 offset:584
    ds_read_b64_tr_b16 v[64:65], v46 offset:4224
    ds_read_b64_tr_b16 v[66:67], v46 offset:4288
    ds_read_b64_tr_b16 v[68:69], v46 offset:4736
    ds_read_b64_tr_b16 v[70:71], v46 offset:4800
    s_waitcnt lgkmcnt(4)
    v_mfma_f32_16x16x32_bf16 v[72:75], v[48:51], v[4:7], 0
    v_mfma_f32_16x16x32_bf16 v[80:83], v[48:51], v[12:15], 0
    v_mfma_f32_16x16x32_bf16 v[72:75], v[52:55], v[8:11], v[72:75]
    v_mfma_f32_16x16x32_bf16 v[80:83], v[52:55], v[16:19], v[80:83]
    v_mfma_f32_16x16x32_bf16 v[76:79], v[56:59], v[4:7], 0
    v_mfma_f32_16x16x32_bf16 v[84:87], v[56:59], v[12:15], 0
    v_mfma_f32_16x16x32_bf16 v[76:79], v[60:63], v[8:11], v[76:79]
    v_mfma_f32_16x16x32_bf16 v[84:87], v[60:63], v[16:19], v[84:87]
    s_waitcnt lgkmcnt(0)
    v_mfma_f32_16x16x32_bf16 v[88:91], v[48:51], v[64:67], 0
    v_mfma_f32_16x16x32_bf16 v[88:91], v[52:55], v[68:71], v[88:91]
    v_mfma_f32_16x16x32_bf16 v[92:95], v[56:59], v[64:67], 0
    v_mfma_f32_16x16x32_bf16 v[92:95], v[60:63], v[68:71], v[92:95]
    v_pk_mul_f32 v[96:97], v[80:81], v[28:29]
    v_pk_mul_f32 v[98:99], v[72:73], v[28:29]
    v_pk_fma_f32 v[72:73], v[72:73], v[20:21], v[96:97] neg_lo:[0,0,1] neg_hi:[0,0,1]
    v_pk_fma_f32 v[80:81], v[80:81], v[20:21], v[98:99]
    v_pk_mul_f32 v[96:97], v[82:83], v[30:31]
    v_pk_mul_f32 v[98:99], v[74:75], v[30:31]
    v_pk_fma_f32 v[74:75], v[74:75], v[22:23], v[96:97] neg_lo:[0,0,1] neg_hi:[0,0,1]
    v_pk_fma_f32 v[82:83], v[82:83], v[22:23], v[98:99]
    v_pk_mul_f32 v[96:97], v[84:85], v[32:33]
    v_pk_mul_f32 v[98:99], v[76:77], v[32:33]
    v_pk_fma_f32 v[76:77], v[76:77], v[24:25], v[96:97] neg_lo:[0,0,1] neg_hi:[0,0,1]
    v_pk_fma_f32 v[84:85], v[84:85], v[24:25], v[98:99]
    v_pk_mul_f32 v[96:97], v[86:87], v[34:35]
    v_pk_mul_f32 v[98:99], v[78:79], v[34:35]
    v_pk_fma_f32 v[78:79], v[78:79], v[26:27], v[96:97] neg_lo:[0,0,1] neg_hi:[0,0,1]
    v_pk_fma_f32 v[86:87], v[86:87], v[26:27], v[98:99]
    v_pk_add_f32 v[100:101], v[72:73], v[76:77]
    v_pk_add_f32 v[102:103], v[74:75], v[78:79]
    v_pk_add_f32 v[104:105], v[80:81], v[84:85]
    v_pk_add_f32 v[106:107], v[82:83], v[86:87]
    v_pk_add_f32 v[108:109], v[72:73], v[76:77] neg_lo:[0,1] neg_hi:[0,1]
    v_pk_add_f32 v[110:111], v[80:81], v[84:85] neg_lo:[0,1] neg_hi:[0,1]
    v_sub_f32 v72, v75, v79
    v_sub_f32 v73, v83, v87
    v_sub_f32 v112, v82, v86
    v_sub_f32 v114, v78, v74
    v_sub_f32 v80, v73, v72
    v_add_f32 v81, v72, v73
    v_mul_f32 v113, 0x3f3504f3, v80
    v_mul_f32 v115, 0xbf3504f3, v81
    v_add_f32 v80, v109, v111
    v_sub_f32 v81, v111, v109
    v_mul_f32 v109, 0x3f3504f3, v80
    v_mul_f32 v111, 0x3f3504f3, v81
    v_pk_add_f32 v[74:75], v[100:101], v[102:103]
    v_pk_add_f32 v[76:77], v[100:101], v[102:103] neg_lo:[0,1] neg_hi:[0,1]
    v_pk_add_f32 v[78:79], v[104:105], v[106:107]
    v_pk_add_f32 v[82:83], v[104:105], v[106:107] neg_lo:[0,1] neg_hi:[0,1]
    v_pk_add_f32 v[100:101], v[74:75], v[74:75] op_sel:[0,1] op_sel_hi:[0,1] neg_hi:[0,1]
    v_pk_add_f32 v[104:105], v[78:79], v[78:79] op_sel:[0,1] op_sel_hi:[0,1] neg_hi:[0,1]
    v_pk_add_f32 v[102:103], v[76:77], v[82:83] op_sel:[0,1] op_sel_hi:[0,1] neg_hi:[0,1]
    v_pk_add_f32 v[106:107], v[82:83], v[76:77] op_sel:[0,1] op_sel_hi:[0,1] neg_lo:[0,1]
    v_pk_add_f32 v[74:75], v[108:109], v[112:113]
    v_pk_add_f32 v[76:77], v[108:109], v[112:113] neg_lo:[0,1] neg_hi:[0,1]
    v_pk_add_f32 v[78:79], v[110:111], v[114:115]
    v_pk_add_f32 v[82:83], v[110:111], v[114:115] neg_lo:[0,1] neg_hi:[0,1]
    v_pk_add_f32 v[108:109], v[74:75], v[74:75] op_sel:[0,1] op_sel_hi:[0,1] neg_hi:[0,1]
    v_pk_add_f32 v[110:111], v[78:79], v[78:79] op_sel:[0,1] op_sel_hi:[0,1] neg_hi:[0,1]
    v_pk_add_f32 v[112:113], v[76:77], v[82:83] op_sel:[0,1] op_sel_hi:[0,1] neg_hi:[0,1]
    v_pk_add_f32 v[114:115], v[82:83], v[76:77] op_sel:[0,1] op_sel_hi:[0,1] neg_lo:[0,1]
    v_cvt_pk_bf16_f32 v48, v100, v104
    v_cvt_pk_bf16_f32 v49, v108, v110
    v_cvt_pk_bf16_f32 v50, v102, v106
    v_cvt_pk_bf16_f32 v51, v112, v114
    v_cvt_pk_bf16_f32 v52, v101, v105
    v_cvt_pk_bf16_f32 v53, v109, v111
    v_cvt_pk_bf16_f32 v54, v103, v107
    v_cvt_pk_bf16_f32 v55, v113, v115
    v_and_b32 v2, 15, v0
    v_lshlrev_b32 v2, 4, v2
    v_lshl_add_u32 v2, v43, 2, v2
    v_add_u32 v2, s7, v2
    ds_write_b32 v2, v48 offset:0
    ds_write_b32 v2, v49 offset:256
    ds_write_b32 v2, v50 offset:512
    ds_write_b32 v2, v51 offset:768
    ds_write_b32 v2, v52 offset:1024
    ds_write_b32 v2, v53 offset:1280
    ds_write_b32 v2, v54 offset:1536
    ds_write_b32 v2, v55 offset:1792
    v_lshl_add_u32 v2, v0, 4, s7
    ds_read_b128 v[56:59], v2
    ds_read_b128 v[60:63], v2 offset:1024
    s_lshl_b32 s26, s5, 12
    s_lshl_b32 s27, s6, 11
    s_add_u32 s26, s26, s27
    s_add_u32 s26, s26, 0
    v_lshl_add_u32 v3, v0, 4, s26
    s_mov_b32 s26, 0x1fff1fff
    s_cmp_eq_u32 s6, 0
    s_cselect_b32 s26, -1, s26
    s_mov_b32 exec_lo, s26
    s_mov_b32 exec_hi, s26
    s_waitcnt lgkmcnt(1)
    global_store_dwordx4 v3, v[56:59], s[24:25] sc1
    s_waitcnt lgkmcnt(0)
    global_store_dwordx4 v3, v[60:63], s[24:25] offset:1024 sc1
    s_mov_b64 exec, -1
    s_cmp_lg_u32 s6, 0
    s_cbranch_scc1 gated_mix__ssm_conv_s4__spectral_gfnet__prompt_kernel_b1_ng
    v_mov_b32 v2, v88
    s_nop 1
    v_add_f32_dpp v2, v89, v2 row_shl:1 row_mask:0xf bank_mask:0xf
    s_nop 1
    v_add_f32_dpp v2, v90, v2 row_shl:2 row_mask:0xf bank_mask:0xf
    s_nop 1
    v_add_f32_dpp v2, v91, v2 row_shl:3 row_mask:0xf bank_mask:0xf
    s_nop 1
    v_add_f32_dpp v2, v92, v2 row_shl:4 row_mask:0xf bank_mask:0xf
    s_nop 1
    v_add_f32_dpp v2, v93, v2 row_shl:5 row_mask:0xf bank_mask:0xf
    s_nop 1
    v_add_f32_dpp v2, v94, v2 row_shl:6 row_mask:0xf bank_mask:0xf
    s_nop 1
    v_add_f32_dpp v2, v95, v2 row_shl:7 row_mask:0xf bank_mask:0xf
    v_cvt_pk_bf16_f32 v2, v2, v2
    v_lshlrev_b32 v2, 16, v2
    v_mul_f32 v2, 0xbfb8aa3b, v2
    v_exp_f32 v2, v2
    s_nop 0
    v_add_f32 v2, 1.0, v2
    v_rcp_f32 v2, v2
    s_nop 0
    v_cvt_pk_bf16_f32 v2, v2, v2
    v_lshlrev_b32 v2, 16, v2
    s_lshl_b32 s26, s5, 4
    s_add_u32 s26, s26, 10485760
    v_lshl_add_u32 v3, v43, 2, s26
    v_and_b32 v4, 15, v0
    v_cmp_eq_u32 vcc, 0, v4
    s_nop 3
    s_and_saveexec_b64 s[28:29], vcc
    global_store_dword v3, v2, s[24:25] sc1
    s_mov_b64 exec, -1
gated_mix__ssm_conv_s4__spectral_gfnet__prompt_kernel_b1_ng:
    s_mov_b64 exec, 1
    ds_add_u32 v127, v126 offset:88
    s_mov_b64 exec, -1
    s_cmp_lg_u32 s4, 0
    s_cbranch_scc1 gated_mix__ssm_conv_s4__spectral_gfnet__prompt_kernel_b1_nf
    s_and_b32 s26, s2, 3
    s_lshl_b32 s26, s26, 6
    v_mov_b32 v3, s26
    s_mov_b32 s59, 0
    s_mov_b64 exec, 1
gated_mix__ssm_conv_s4__spectral_gfnet__prompt_kernel_b1_n2:
    global_load_dword v4, v3, s[60:61] sc1
    s_waitcnt vmcnt(0)
    v_readfirstlane_b32 s50, v4
    s_nop 3
    s_cmp_lg_u32 s50, 0
    s_cbranch_scc1 gated_mix__ssm_conv_s4__spectral_gfnet__prompt_kernel_b1_n3
    s_add_u32 s59, s59, 1
    s_cmp_gt_u32 s59, 131072
    s_cbranch_scc1 gated_mix__ssm_conv_s4__spectral_gfnet__prompt_kernel_b1_n3
    s_sleep 8
    s_branch gated_mix__ssm_conv_s4__spectral_gfnet__prompt_kernel_b1_n2
gated_mix__ssm_conv_s4__spectral_gfnet__prompt_kernel_b1_n3:
    ds_write_b32 v127, v4 offset:80
    s_waitcnt lgkmcnt(0)
    s_mov_b64 exec, -1
gated_mix__ssm_conv_s4__spectral_gfnet__prompt_kernel_b1_nf:
    s_waitcnt vmcnt(0)
    s_mov_b64 exec, 1
    ds_add_rtn_u32 v124, v127, v126 offset:0
    s_waitcnt lgkmcnt(0)
    v_readfirstlane_b32 s58, v124
    s_mov_b64 exec, -1
    s_nop 2
    s_cmp_eq_u32 s58, 7
    s_cbranch_scc0 Ln19
    s_mov_b32 s59, 0
Lk20:
    ds_read_b32 v124, v127 offset:80
    s_waitcnt lgkmcnt(0)
    v_readfirstlane_b32 s57, v124
    s_nop 3
    s_cmp_lg_u32 s57, 0
    s_cbranch_scc1 Ll21
    s_add_u32 s59, s59, 1
    s_cmp_gt_u32 s59, 2097152
    s_cbranch_scc1 Ll21
    s_sleep 1
    s_branch Lk20
Ll21:
    s_lshl_b32 s58, s2, 6
    s_add_u32 s58, s58, 15728640
    v_mbcnt_lo_u32_b32 v124, -1, 0
    v_mul_u32_u24 v124, 16384, v124
    v_add_u32 v124, s58, v124
    v_mov_b32 v125, s57
    s_mov_b64 exec, 1
    global_store_dword v124, v125, s[24:25] sc1
    s_mov_b64 exec, -1
Ln19:
    s_setprio 0
    s_cmp_ge_u32 s2, 232
    s_cbranch_scc1 gated_mix__ssm_conv_s4__spectral_gfnet__prompt_kernel_p3
    s_and_b32 s5, s2, 7
    s_lshr_b32 s6, s2, 3
    s_lshl_b32 s26, s5, 5
    s_add_u32 s26, s26, s6
    s_lshl_b32 s28, s26, 13
    v_and_b32 v122, 15, v0
    v_lshrrev_b32 v123, 4, v0
    v_lshrrev_b32 v3, 1, v122
    v_lshlrev_b32 v3, 6, v3
    v_and_b32 v4, 1, v122
    v_lshl_add_u32 v3, v4, 4, v3
    v_lshl_add_u32 v3, v123, 9, v3
    s_lshl_b32 s29, s4, 11
    s_add_u32 s29, s29, s28
    s_add_u32 s29, s29, 2097152
    v_add_u32 v3, s29, v3
    s_lshl_b32 s30, s4, 4
    v_add_u32 v25, s30, v122
    v_cvt_f32_u32 v26, v25
    v_cvt_f32_u32 v27, v123
    v_mul_f32 v28, 4.0, v27
    v_mul_f32 v20, 0x3c800000, v26
    v_mul_f32 v21, v20, v28
    v_fmamk_f32 v22, v20, 0x00000000, v21
    v_cos_f32 v23, v22
    v_sin_f32 v24, v22
    s_nop 0
    v_cvt_pk_bf16_f32 v32, v23, v24
    v_cvt_pk_bf16_f32 v48, -v24, v23
    v_fmamk_f32 v22, v20, 0x40000000, v21
    v_cos_f32 v23, v22
    v_sin_f32 v24, v22
    s_nop 0
    v_cvt_pk_bf16_f32 v33, v23, v24
    v_cvt_pk_bf16_f32 v49, -v24, v23
    v_fmamk_f32 v22, v20, 0x3f800000, v21
    v_cos_f32 v23, v22
    v_sin_f32 v24, v22
    s_nop 0
    v_cvt_pk_bf16_f32 v34, v23, v24
    v_cvt_pk_bf16_f32 v50, -v24, v23
    v_fmamk_f32 v22, v20, 0x40400000, v21
    v_cos_f32 v23, v22
    v_sin_f32 v24, v22
    s_nop 0
    v_cvt_pk_bf16_f32 v35, v23, v24
    v_cvt_pk_bf16_f32 v51, -v24, v23
    v_fmamk_f32 v22, v20, 0x41800000, v21
    v_cos_f32 v23, v22
    v_sin_f32 v24, v22
    s_nop 0
    v_cvt_pk_bf16_f32 v36, v23, v24
    v_cvt_pk_bf16_f32 v52, -v24, v23
    v_fmamk_f32 v22, v20, 0x41900000, v21
    v_cos_f32 v23, v22
    v_sin_f32 v24, v22
    s_nop 0
    v_cvt_pk_bf16_f32 v37, v23, v24
    v_cvt_pk_bf16_f32 v53, -v24, v23
    v_fmamk_f32 v22, v20, 0x41880000, v21
    v_cos_f32 v23, v22
    v_sin_f32 v24, v22
    s_nop 0
    v_cvt_pk_bf16_f32 v38, v23, v24
    v_cvt_pk_bf16_f32 v54, -v24, v23
    v_fmamk_f32 v22, v20, 0x41980000, v21
    v_cos_f32 v23, v22
    v_sin_f32 v24, v22
    s_nop 0
    v_cvt_pk_bf16_f32 v39, v23, v24
    v_cvt_pk_bf16_f32 v55, -v24, v23
    v_fmamk_f32 v22, v20, 0x42000000, v21
    v_cos_f32 v23, v22
    v_sin_f32 v24, v22
    s_nop 0
    v_cvt_pk_bf16_f32 v40, v23, v24
    v_cvt_pk_bf16_f32 v56, -v24, v23
    v_fmamk_f32 v22, v20, 0x42080000, v21
    v_cos_f32 v23, v22
    v_sin_f32 v24, v22
    s_nop 0
    v_cvt_pk_bf16_f32 v41, v23, v24
    v_cvt_pk_bf16_f32 v57, -v24, v23
    v_fmamk_f32 v22, v20, 0x42040000, v21
    v_cos_f32 v23, v22
    v_sin_f32 v24, v22
    s_nop 0
    v_cvt_pk_bf16_f32 v42, v23, v24
    v_cvt_pk_bf16_f32 v58, -v24, v23
    v_fmamk_f32 v22, v20, 0x420c0000, v21
    v_cos_f32 v23, v22
    v_sin_f32 v24, v22
    s_nop 0
    v_cvt_pk_bf16_f32 v43, v23, v24
    v_cvt_pk_bf16_f32 v59, -v24, v23
    v_fmamk_f32 v22, v20, 0x42400000, v21
    v_cos_f32 v23, v22
    v_sin_f32 v24, v22
    s_nop 0
    v_cvt_pk_bf16_f32 v44, v23, v24
    v_cvt_pk_bf16_f32 v60, -v24, v23
    v_fmamk_f32 v22, v20, 0x42480000, v21
    v_cos_f32 v23, v22
    v_sin_f32 v24, v22
    s_nop 0
    v_cvt_pk_bf16_f32 v45, v23, v24
    v_cvt_pk_bf16_f32 v61, -v24, v23
    v_fmamk_f32 v22, v20, 0x42440000, v21
    v_cos_f32 v23, v22
    v_sin_f32 v24, v22
    s_nop 0
    v_cvt_pk_bf16_f32 v46, v23, v24
    v_cvt_pk_bf16_f32 v62, -v24, v23
    v_fmamk_f32 v22, v20, 0x424c0000, v21
    v_cos_f32 v23, v22
    v_sin_f32 v24, v22
    s_nop 0
    v_cvt_pk_bf16_f32 v47, v23, v24
    v_cvt_pk_bf16_f32 v63, -v24, v23
    v_cvt_f32_u32 v29, v122
    v_mul_f32 v20, 0x3d000000, v29
    v_mul_f32 v21, v20, v28
    v_fmamk_f32 v22, v20, 0x00000000, v21
    v_fmamk_f32 v30, v20, 0x3f800000, v21
    v_cos_f32 v23, v22
    v_cos_f32 v24, v30
    v_sin_f32 v22, v22
    v_sin_f32 v30, v30
    v_cvt_pk_bf16_f32 v64, v23, v24
    v_cvt_pk_bf16_f32 v72, v22, v30
    v_fmamk_f32 v22, v20, 0x40000000, v21
    v_fmamk_f32 v30, v20, 0x40400000, v21
    v_cos_f32 v23, v22
    v_cos_f32 v24, v30
    v_sin_f32 v22, v22
    v_sin_f32 v30, v30
    v_cvt_pk_bf16_f32 v65, v23, v24
    v_cvt_pk_bf16_f32 v73, v22, v30
    v_fmamk_f32 v22, v20, 0x41800000, v21
    v_fmamk_f32 v30, v20, 0x41880000, v21
    v_cos_f32 v23, v22
    v_cos_f32 v24, v30
    v_sin_f32 v22, v22
    v_sin_f32 v30, v30
    v_cvt_pk_bf16_f32 v66, v23, v24
    v_cvt_pk_bf16_f32 v74, v22, v30
    v_fmamk_f32 v22, v20, 0x41900000, v21
    v_fmamk_f32 v30, v20, 0x41980000, v21
    v_cos_f32 v23, v22
    v_cos_f32 v24, v30
    v_sin_f32 v22, v22
    v_sin_f32 v30, v30
    v_cvt_pk_bf16_f32 v67, v23, v24
    v_cvt_pk_bf16_f32 v75, v22, v30
    v_cvt_f32_u32 v29, v122
    v_add_f32 v29, 0x41800000, v29
    v_mul_f32 v20, 0x3d000000, v29
    v_mul_f32 v21, v20, v28
    v_fmamk_f32 v22, v20, 0x00000000, v21
    v_fmamk_f32 v30, v20, 0x3f800000, v21
    v_cos_f32 v23, v22
    v_cos_f32 v24, v30
    v_sin_f32 v22, v22
    v_sin_f32 v30, v30
    v_cvt_pk_bf16_f32 v68, v23, v24
    v_cvt_pk_bf16_f32 v76, v22, v30
    v_fmamk_f32 v22, v20, 0x40000000, v21
    v_fmamk_f32 v30, v20, 0x40400000, v21
    v_cos_f32 v23, v22
    v_cos_f32 v24, v30
    v_sin_f32 v22, v22
    v_sin_f32 v30, v30
    v_cvt_pk_bf16_f32 v69, v23, v24
    v_cvt_pk_bf16_f32 v77, v22, v30
    v_fmamk_f32 v22, v20, 0x41800000, v21
    v_fmamk_f32 v30, v20, 0x41880000, v21
    v_cos_f32 v23, v22
    v_cos_f32 v24, v30
    v_sin_f32 v22, v22
    v_sin_f32 v30, v30
    v_cvt_pk_bf16_f32 v70, v23, v24
    v_cvt_pk_bf16_f32 v78, v22, v30
    v_fmamk_f32 v22, v20, 0x41900000, v21
    v_fmamk_f32 v30, v20, 0x41980000, v21
    v_cos_f32 v23, v22
    v_cos_f32 v24, v30
    v_sin_f32 v22, v22
    v_sin_f32 v30, v30
    v_cvt_pk_bf16_f32 v71, v23, v24
    v_cvt_pk_bf16_f32 v79, v22, v30
    v_mul_f32 v20, 0xba000000, v26
    v_mul_f32 v21, v20, v28
    v_fmamk_f32 v22, v20, 0x00000000, v21
    v_cos_f32 v80, v22
    v_sin_f32 v88, v22
    v_fmamk_f32 v22, v20, 0x3f800000, v21
    v_cos_f32 v81, v22
    v_sin_f32 v89, v22
    v_fmamk_f32 v22, v20, 0x40000000, v21
    v_cos_f32 v82, v22
    v_sin_f32 v90, v22
    v_fmamk_f32 v22, v20, 0x40400000, v21
    v_cos_f32 v83, v22
    v_sin_f32 v91, v22
    v_fmamk_f32 v22, v20, 0x41800000, v21
    v_cos_f32 v84, v22
    v_sin_f32 v92, v22
    v_fmamk_f32 v22, v20, 0x41880000, v21
    v_cos_f32 v85, v22
    v_sin_f32 v93, v22
    v_fmamk_f32 v22, v20, 0x41900000, v21
    v_cos_f32 v86, v22
    v_sin_f32 v94, v22
    v_fmamk_f32 v22, v20, 0x41980000, v21
    v_cos_f32 v87, v22
    v_sin_f32 v95, v22
    v_cvt_f32_u32 v29, s30
    v_add_f32 v29, v29, v28
    v_lshl_add_u32 v31, v0, 4, s7
    v_cvt_f32_u32 v30, v122
    v_mul_f32 v20, 0xba000000, v30
    v_mul_f32 v21, v20, v29
    v_mov_b32 v22, v21
    v_cos_f32 v96, v22
    v_sin_f32 v100, v22
    v_fmamk_f32 v22, v20, 0x3f800000, v21
    v_cos_f32 v97, v22
    v_sin_f32 v101, v22
    v_fmamk_f32 v22, v20, 0x40000000, v21
    v_cos_f32 v98, v22
    v_sin_f32 v102, v22
    v_fmamk_f32 v22, v20, 0x40400000, v21
    v_cos_f32 v99, v22
    v_sin_f32 v103, v22
    ds_write_b128 v31, v[96:99] offset:0
    ds_write_b128 v31, v[100:103] offset:1024
    v_cvt_f32_u32 v30, v122
    v_add_f32 v30, 0x41800000, v30
    v_mul_f32 v20, 0xba000000, v30
    v_mul_f32 v21, v20, v29
    v_mov_b32 v22, v21
    v_cos_f32 v96, v22
    v_sin_f32 v100, v22
    v_fmamk_f32 v22, v20, 0x3f800000, v21
    v_cos_f32 v97, v22
    v_sin_f32 v101, v22
    v_fmamk_f32 v22, v20, 0x40000000, v21
    v_cos_f32 v98, v22
    v_sin_f32 v102, v22
    v_fmamk_f32 v22, v20, 0x40400000, v21
    v_cos_f32 v99, v22
    v_sin_f32 v103, v22
    ds_write_b128 v31, v[96:99] offset:2048
    ds_write_b128 v31, v[100:103] offset:3072
    v_and_b32 v4, 1, v123
    v_lshlrev_b32 v5, 2, v122
    v_lshl_add_u32 v5, v123, 9, v5
    v_add_u32 v5, 70528, v5
    v_lshl_add_u32 v1, v4, 6, v5
    v_xor_b32 v4, 1, v4
    v_lshl_add_u32 v2, v4, 6, v5
    v_add_u32 v120, 128, v1
    v_add_u32 v121, 128, v2
    s_mov_b32 s59, 0
Lw22:
    ds_read_b32 v124, v127 offset:12
    s_waitcnt lgkmcnt(0)
    v_readfirstlane_b32 s58, v124
    s_nop 3
    s_cmp_ge_u32 s58, 1
    s_cbranch_scc1 Le23
    s_add_u32 s59, s59, 1
    s_cmp_gt_u32 s59, 2097152
    s_cbranch_scc1 Le23
    s_sleep 1
    s_branch Lw22
Le23:
    s_setprio 2
    global_load_dwordx4 v[12:15], v3, s[24:25] sc1
    global_load_dwordx4 v[16:19], v3, s[24:25] offset:32 sc1
    s_mov_b32 s59, 0
Lw24:
    ds_read_b32 v124, v127 offset:24
    s_waitcnt lgkmcnt(0)
    v_readfirstlane_b32 s58, v124
    s_nop 3
    s_cmp_ge_u32 s58, 1
    s_cbranch_scc1 Le25
    s_add_u32 s59, s59, 1
    s_cmp_gt_u32 s59, 2097152
    s_cbranch_scc1 Le25
    s_sleep 1
    s_branch Lw24
Le25:
    ds_read2st64_b32 v[96:97], v1 offset0:0 offset1:1
    ds_read2st64_b32 v[98:99], v120 offset0:0 offset1:1
    ds_read2st64_b32 v[100:101], v1 offset0:8 offset1:9
    ds_read2st64_b32 v[102:103], v120 offset0:8 offset1:9
    ds_read2st64_b32 v[104:105], v1 offset0:16 offset1:17
    ds_read2st64_b32 v[106:107], v120 offset0:16 offset1:17
    s_waitcnt lgkmcnt(4)
    v_mfma_f32_16x16x32_bf16 v[28:31], v[96:99], v[32:35], 0
    ds_read2st64_b32 v[108:109], v1 offset0:24 offset1:25
    v_mfma_f32_16x16x32_bf16 v[4:7], v[96:99], v[48:51], 0
    ds_read2st64_b32 v[110:111], v120 offset0:24 offset1:25
    s_waitcnt lgkmcnt(4)
    v_mfma_f32_16x16x32_bf16 v[28:31], v[100:103], v[36:39], v[28:31]
    ds_read2st64_b32 v[8:9], v2 offset0:0 offset1:1
    v_mfma_f32_16x16x32_bf16 v[4:7], v[100:103], v[52:55], v[4:7]
    ds_read2st64_b32 v[10:11], v121 offset0:0 offset1:1
    s_waitcnt lgkmcnt(4)
    v_mfma_f32_16x16x32_bf16 v[28:31], v[104:107], v[40:43], v[28:31]
    ds_read2st64_b32 v[20:21], v2 offset0:8 offset1:9
    v_mfma_f32_16x16x32_bf16 v[4:7], v[104:107], v[56:59], v[4:7]
    ds_read2st64_b32 v[22:23], v121 offset0:8 offset1:9
    s_waitcnt lgkmcnt(4)
    v_mfma_f32_16x16x32_bf16 v[28:31], v[108:111], v[44:47], v[28:31]
    ds_read2st64_b32 v[24:25], v2 offset0:16 offset1:17
    v_mfma_f32_16x16x32_bf16 v[4:7], v[108:111], v[60:63], v[4:7]
    ds_read2st64_b32 v[26:27], v121 offset0:16 offset1:17
    s_waitcnt lgkmcnt(4)
    v_mfma_f32_16x16x32_bf16 v[112:115], v[8:11], v[32:35], 0
    ds_read2st64_b32 v[96:97], v2 offset0:24 offset1:25
    v_mfma_f32_16x16x32_bf16 v[116:119], v[8:11], v[48:51], 0
    ds_read2st64_b32 v[98:99], v121 offset0:24 offset1:25
    s_waitcnt lgkmcnt(4)
    v_mfma_f32_16x16x32_bf16 v[112:115], v[20:23], v[36:39], v[112:115]
    v_mfma_f32_16x16x32_bf16 v[116:119], v[20:23], v[52:55], v[116:119]
    s_waitcnt lgkmcnt(2)
    v_mfma_f32_16x16x32_bf16 v[112:115], v[24:27], v[40:43], v[112:115]
    v_mfma_f32_16x16x32_bf16 v[116:119], v[24:27], v[56:59], v[116:119]
    s_waitcnt lgkmcnt(0)
    v_mfma_f32_16x16x32_bf16 v[112:115], v[96:99], v[44:47], v[112:115]
    v_mfma_f32_16x16x32_bf16 v[116:119], v[96:99], v[60:63], v[116:119]
    v_pk_mul_f32 v[96:97], v[4:5], v[88:89]
    v_pk_mul_f32 v[98:99], v[28:29], v[88:89]
    v_pk_fma_f32 v[28:29], v[28:29], v[80:81], v[96:97] neg_lo:[0,0,1] neg_hi:[0,0,1]
    v_pk_fma_f32 v[4:5], v[4:5], v[80:81], v[98:99]
    v_pk_mul_f32 v[96:97], v[6:7], v[90:91]
    v_pk_mul_f32 v[98:99], v[30:31], v[90:91]
    v_pk_fma_f32 v[30:31], v[30:31], v[82:83], v[96:97] neg_lo:[0,0,1] neg_hi:[0,0,1]
    v_pk_fma_f32 v[6:7], v[6:7], v[82:83], v[98:99]
    v_pk_mul_f32 v[96:97], v[116:117], v[92:93]
    v_pk_mul_f32 v[98:99], v[112:113], v[92:93]
    v_pk_fma_f32 v[112:113], v[112:113], v[84:85], v[96:97] neg_lo:[0,0,1] neg_hi:[0,0,1]
    v_pk_fma_f32 v[116:117], v[116:117], v[84:85], v[98:99]
    v_pk_mul_f32 v[96:97], v[118:119], v[94:95]
    v_pk_mul_f32 v[98:99], v[114:115], v[94:95]
    v_pk_fma_f32 v[114:115], v[114:115], v[86:87], v[96:97] neg_lo:[0,0,1] neg_hi:[0,0,1]
    v_pk_fma_f32 v[118:119], v[118:119], v[86:87], v[98:99]
    v_cvt_pk_bf16_f32 v100, v28, v29
    v_cvt_pk_bf16_f32 v104, v4, v5
    v_cvt_pk_bf16_f32 v108, -v28, -v29
    v_cvt_pk_bf16_f32 v101, v30, v31
    v_cvt_pk_bf16_f32 v105, v6, v7
    v_cvt_pk_bf16_f32 v109, -v30, -v31
    v_cvt_pk_bf16_f32 v102, v112, v113
    v_cvt_pk_bf16_f32 v106, v116, v117
    v_cvt_pk_bf16_f32 v110, -v112, -v113
    v_cvt_pk_bf16_f32 v103, v114, v115
    v_cvt_pk_bf16_f32 v107, v118, v119
    v_cvt_pk_bf16_f32 v111, -v114, -v115
    v_mfma_f32_16x16x32_bf16 v[28:31], v[64:67], v[100:103], 0
    v_mfma_f32_16x16x32_bf16 v[4:7], v[64:67], v[104:107], 0
    v_mfma_f32_16x16x32_bf16 v[28:31], v[72:75], v[104:107], v[28:31]
    v_mfma_f32_16x16x32_bf16 v[4:7], v[72:75], v[108:111], v[4:7]
    v_mfma_f32_16x16x32_bf16 v[112:115], v[68:71], v[100:103], 0
    v_mfma_f32_16x16x32_bf16 v[116:119], v[68:71], v[104:107], 0
    v_mfma_f32_16x16x32_bf16 v[112:115], v[76:79], v[104:107], v[112:115]
    v_mfma_f32_16x16x32_bf16 v[116:119], v[76:79], v[108:111], v[116:119]
    v_lshl_add_u32 v1, v0, 4, s7
    ds_read_b128 v[80:83], v1 offset:0
    ds_read_b128 v[88:91], v1 offset:1024
    ds_read_b128 v[84:87], v1 offset:2048
    ds_read_b128 v[92:95], v1 offset:3072
    s_waitcnt vmcnt(0)
    v_lshlrev_b32 v20, 16, v12
    v_and_b32 v24, 0xffff0000, v12
    v_lshlrev_b32 v21, 16, v13
    v_and_b32 v25, 0xffff0000, v13
    v_lshlrev_b32 v22, 16, v14
    v_and_b32 v26, 0xffff0000, v14
    v_lshlrev_b32 v23, 16, v15
    v_and_b32 v27, 0xffff0000, v15
    v_pk_mul_f32 v[96:97], v[4:5], v[24:25]
    v_pk_mul_f32 v[98:99], v[28:29], v[24:25]
    v_pk_fma_f32 v[28:29], v[28:29], v[20:21], v[96:97] neg_lo:[0,0,1] neg_hi:[0,0,1]
    v_pk_fma_f32 v[4:5], v[4:5], v[20:21], v[98:99]
    v_pk_mul_f32 v[96:97], v[6:7], v[26:27]
    v_pk_mul_f32 v[98:99], v[30:31], v[26:27]
    v_pk_fma_f32 v[30:31], v[30:31], v[22:23], v[96:97] neg_lo:[0,0,1] neg_hi:[0,0,1]
    v_pk_fma_f32 v[6:7], v[6:7], v[22:23], v[98:99]
    v_lshlrev_b32 v20, 16, v16
    v_and_b32 v24, 0xffff0000, v16
    v_lshlrev_b32 v21, 16, v17
    v_and_b32 v25, 0xffff0000, v17
    v_lshlrev_b32 v22, 16, v18
    v_and_b32 v26, 0xffff0000, v18
    v_lshlrev_b32 v23, 16, v19
    v_and_b32 v27, 0xffff0000, v19
    v_pk_mul_f32 v[96:97], v[116:117], v[24:25]
    v_pk_mul_f32 v[98:99], v[112:113], v[24:25]
    v_pk_fma_f32 v[112:113], v[112:113], v[20:21], v[96:97] neg_lo:[0,0,1] neg_hi:[0,0,1]
    v_pk_fma_f32 v[116:117], v[116:117], v[20:21], v[98:99]
    v_pk_mul_f32 v[96:97], v[118:119], v[26:27]
    v_pk_mul_f32 v[98:99], v[114:115], v[26:27]
    v_pk_fma_f32 v[114:115], v[114:115], v[22:23], v[96:97] neg_lo:[0,0,1] neg_hi:[0,0,1]
    v_pk_fma_f32 v[118:119], v[118:119], v[22:23], v[98:99]
    v_cvt_pk_bf16_f32 v100, v28, v29
    v_cvt_pk_bf16_f32 v104, -v4, -v5
    v_cvt_pk_bf16_f32 v108, -v28, -v29
    v_cvt_pk_bf16_f32 v101, v30, v31
    v_cvt_pk_bf16_f32 v105, -v6, -v7
    v_cvt_pk_bf16_f32 v109, -v30, -v31
    v_cvt_pk_bf16_f32 v102, v112, v113
    v_cvt_pk_bf16_f32 v106, -v116, -v117
    v_cvt_pk_bf16_f32 v110, -v112, -v113
    v_cvt_pk_bf16_f32 v103, v114, v115
    v_cvt_pk_bf16_f32 v107, -v118, -v119
    v_cvt_pk_bf16_f32 v111, -v114, -v115
    v_mfma_f32_16x16x32_bf16 v[28:31], v[100:103], v[64:67], 0
    v_mfma_f32_16x16x32_bf16 v[4:7], v[104:107], v[64:67], 0
    v_mfma_f32_16x16x32_bf16 v[28:31], v[104:107], v[72:75], v[28:31]
    v_mfma_f32_16x16x32_bf16 v[4:7], v[108:111], v[72:75], v[4:7]
    v_mfma_f32_16x16x32_bf16 v[112:115], v[100:103], v[68:71], 0
    v_mfma_f32_16x16x32_bf16 v[116:119], v[104:107], v[68:71], 0
    v_mfma_f32_16x16x32_bf16 v[112:115], v[104:107], v[76:79], v[112:115]
    v_mfma_f32_16x16x32_bf16 v[116:119], v[108:111], v[76:79], v[116:119]
    v_mul_u32_u24 v2, 288, v122
    s_lshl_b32 s30, s4, 6
    s_add_u32 s30, s30, 78720
    v_lshl_add_u32 v2, v123, 4, v2
    v_add_u32 v1, s30, v2
    v_add_u32 v2, 78720, v2
    s_waitcnt lgkmcnt(0)
    v_pk_mul_f32 v[96:97], v[4:5], v[88:89]
    v_pk_mul_f32 v[98:99], v[28:29], v[88:89]
    v_pk_fma_f32 v[28:29], v[28:29], v[80:81], v[96:97] neg_lo:[0,0,1] neg_hi:[0,0,1]
    v_pk_fma_f32 v[4:5], v[4:5], v[80:81], v[98:99]
    v_pk_mul_f32 v[96:97], v[6:7], v[90:91]
    v_pk_mul_f32 v[98:99], v[30:31], v[90:91]
    v_pk_fma_f32 v[30:31], v[30:31], v[82:83], v[96:97] neg_lo:[0,0,1] neg_hi:[0,0,1]
    v_pk_fma_f32 v[6:7], v[6:7], v[82:83], v[98:99]
    v_cvt_pk_bf16_f32 v12, v28, v4
    v_cvt_pk_bf16_f32 v13, v30, v6
    v_cvt_pk_bf16_f32 v14, v29, v5
    v_cvt_pk_bf16_f32 v15, v31, v7
    ds_write_b128 v1, v[12:15] offset:0
    v_pk_mul_f32 v[96:97], v[116:117], v[92:93]
    v_pk_mul_f32 v[98:99], v[112:113], v[92:93]
    v_pk_fma_f32 v[112:113], v[112:113], v[84:85], v[96:97] neg_lo:[0,0,1] neg_hi:[0,0,1]
    v_pk_fma_f32 v[116:117], v[116:117], v[84:85], v[98:99]
    v_pk_mul_f32 v[96:97], v[118:119], v[94:95]
    v_pk_mul_f32 v[98:99], v[114:115], v[94:95]
    v_pk_fma_f32 v[114:115], v[114:115], v[86:87], v[96:97] neg_lo:[0,0,1] neg_hi:[0,0,1]
    v_pk_fma_f32 v[118:119], v[118:119], v[86:87], v[98:99]
    v_cvt_pk_bf16_f32 v16, v112, v116
    v_cvt_pk_bf16_f32 v17, v114, v118
    v_cvt_pk_bf16_f32 v18, v113, v117
    v_cvt_pk_bf16_f32 v19, v115, v119
    ds_write_b128 v1, v[16:19] offset:4608
    s_waitcnt lgkmcnt(0)
    s_mov_b64 exec, 1
    ds_add_u32 v127, v126 offset:68
    s_mov_b64 exec, -1
    s_mov_b32 s59, 0
Lw26:
    ds_read_b32 v124, v127 offset:68
    s_waitcnt lgkmcnt(0)
    v_readfirstlane_b32 s58, v124
    s_nop 3
    s_cmp_ge_u32 s58, 4
    s_cbranch_scc1 Le27
    s_add_u32 s59, s59, 1
    s_cmp_gt_u32 s59, 2097152
    s_cbranch_scc1 Le27
    s_sleep 1
    s_branch Lw26
Le27:
    ds_read_b128 v[96:99], v2 offset:0
    ds_read_b128 v[100:103], v2 offset:64
    ds_read_b128 v[104:107], v2 offset:128
    ds_read_b128 v[108:111], v2 offset:192
    s_waitcnt lgkmcnt(3)
    v_mfma_f32_16x16x32_bf16 v[28:31], v[96:99], v[32:35], 0
    ds_read_b128 v[80:83], v2 offset:4608
    v_mfma_f32_16x16x32_bf16 v[4:7], v[96:99], v[48:51], 0
    s_waitcnt lgkmcnt(3)
    v_mfma_f32_16x16x32_bf16 v[28:31], v[100:103], v[36:39], v[28:31]
    ds_read_b128 v[84:87], v2 offset:4672
    v_mfma_f32_16x16x32_bf16 v[4:7], v[100:103], v[52:55], v[4:7]
    s_waitcnt lgkmcnt(3)
    v_mfma_f32_16x16x32_bf16 v[28:31], v[104:107], v[40:43], v[28:31]
    ds_read_b128 v[88:91], v2 offset:4736
    v_mfma_f32_16x16x32_bf16 v[4:7], v[104:107], v[56:59], v[4:7]
    s_waitcnt lgkmcnt(3)
    v_mfma_f32_16x16x32_bf16 v[28:31], v[108:111], v[44:47], v[28:31]
    ds_read_b128 v[92:95], v2 offset:4800
    v_mfma_f32_16x16x32_bf16 v[4:7], v[108:111], v[60:63], v[4:7]
    s_waitcnt lgkmcnt(3)
    v_mfma_f32_16x16x32_bf16 v[112:115], v[80:83], v[32:35], 0
    v_mfma_f32_16x16x32_bf16 v[116:119], v[80:83], v[48:51], 0
    s_waitcnt lgkmcnt(2)
    v_mfma_f32_16x16x32_bf16 v[112:115], v[84:87], v[36:39], v[112:115]
    v_mfma_f32_16x16x32_bf16 v[116:119], v[84:87], v[52:55], v[116:119]
    s_waitcnt lgkmcnt(1)
    v_mfma_f32_16x16x32_bf16 v[112:115], v[88:91], v[40:43], v[112:115]
    v_mfma_f32_16x16x32_bf16 v[116:119], v[88:91], v[56:59], v[116:119]
    s_waitcnt lgkmcnt(0)
    v_mfma_f32_16x16x32_bf16 v[112:115], v[92:95], v[44:47], v[112:115]
    v_mfma_f32_16x16x32_bf16 v[116:119], v[92:95], v[60:63], v[116:119]
    s_mov_b32 s59, 0
Lw28:
    ds_read_b32 v124, v127 offset:100
    s_waitcnt lgkmcnt(0)
    v_readfirstlane_b32 s58, v124
    s_nop 3
    s_cmp_ge_u32 s58, 2
    s_cbranch_scc1 Le29
    s_add_u32 s59, s59, 1
    s_cmp_gt_u32 s59, 2097152
    s_cbranch_scc1 Le29
    s_sleep 1
    s_branch Lw28
Le29:
    v_lshlrev_b32 v1, 7, v122
    v_lshl_add_u32 v1, v123, 4, v1
    s_lshl_b32 s30, s4, 11
    s_add_u32 s30, s30, s28
    s_add_u32 s30, s30, 11534336
    v_add_u32 v1, s30, v1
    v_cvt_pk_bf16_f32 v12, v28, -v4
    v_cvt_pk_bf16_f32 v13, v29, -v5
    v_cvt_pk_bf16_f32 v14, v30, -v6
    v_cvt_pk_bf16_f32 v15, v31, -v7
    global_store_dwordx4 v1, v[12:15], s[24:25] offset:0 sc1
    v_cvt_pk_bf16_f32 v16, v112, -v116
    v_cvt_pk_bf16_f32 v17, v113, -v117
    v_cvt_pk_bf16_f32 v18, v114, -v118
    v_cvt_pk_bf16_f32 v19, v115, -v119
    global_store_dwordx4 v1, v[16:19], s[24:25] offset:64 sc1
    s_mov_b64 exec, 1
    ds_add_u32 v127, v126 offset:116
    s_mov_b64 exec, -1
    s_setprio 3
gated_mix__ssm_conv_s4__spectral_gfnet__prompt_kernel_p3:
    s_load_dwordx2 s[8:9], s[0:1], 104
    v_lshl_add_u32 v88, s4, 6, v0
    s_and_b32 s5, s2, 7
    s_lshl_b32 s5, s5, 5
    s_lshr_b32 s6, s2, 3
    s_add_u32 s5, s5, s6
    v_and_b32 v2, 7, v0
    v_lshrrev_b32 v3, 3, v0
    s_lshl_b32 s6, s4, 3
    v_add_u32 v3, s6, v3
    v_lshlrev_b32 v92, 13, v3
    v_lshl_add_u32 v92, v2, 2, v92
    s_lshl_b32 s6, s5, 5
    v_add_u32 v92, s6, v92
    v_cmp_lt_u32 vcc, 28, v3
    v_mov_b32 v5, 0x7ff00000
    s_nop 0
    v_cndmask_b32 v92, v92, v5, vcc
    s_add_u32 s10, s24, 11534336
    s_addc_u32 s11, s25, 0
    s_lshl_b32 s26, s5, 5
    s_add_u32 s26, s26, 10485760
    v_lshl_add_u32 v93, v2, 2, s26
    s_mov_b32 s12, s10
    s_and_b32 s13, s11, 0xffff
    s_mov_b32 s14, 2097152
    s_mov_b32 s15, 0x00020000
    v_cvt_f32_u32 v32, v3
    v_mul_f32 v32, 0x3b124925, v32
    v_mov_b32 v16, 1.0
    v_mov_b32 v24, 0
    v_mul_f32 v33, 0x3f800000, v32
    v_cos_f32 v20, v33
    v_sin_f32 v28, v33
    v_mul_f32 v33, 0x40000000, v32
    v_cos_f32 v18, v33
    v_sin_f32 v26, v33
    v_mul_f32 v33, 0x40400000, v32
    v_cos_f32 v22, v33
    v_sin_f32 v30, v33
    v_mul_f32 v33, 0x40800000, v32
    v_cos_f32 v17, v33
    v_sin_f32 v25, v33
    v_mul_f32 v33, 0x40a00000, v32
    v_cos_f32 v21, v33
    v_sin_f32 v29, v33
    v_mul_f32 v33, 0x40c00000, v32
    v_cos_f32 v19, v33
    v_sin_f32 v27, v33
    v_mul_f32 v33, 0x40e00000, v32
    v_cos_f32 v23, v33
    v_sin_f32 v31, v33
    v_and_b32 v90, 15, v0
    v_lshrrev_b32 v91, 4, v0
    v_and_b32 v36, 3, v90
    v_lshlrev_b32 v36, 2, v36
    v_lshrrev_b32 v37, 2, v90
    v_add_u32 v36, v36, v37
    s_lshl_b32 s26, s4, 4
    v_add_u32 v36, s26, v36
    v_cvt_f32_u32 v37, v36
    v_mul_f32 v37, 0x3c924925, v37
    v_lshlrev_b32 v38, 2, v91
    v_cvt_f32_u32 v39, v38
    v_mul_f32 v40, v37, v39
    v_cmp_gt_u32 vcc, 56, v36
    v_mov_b32 v41, 0x36124925
    s_nop 0
    v_cndmask_b32 v41, 0, v41, vcc
    v_mul_f32 v45, 0.5, v41
    v_cmp_eq_u32 vcc, 0, v91
    s_nop 1
    v_cndmask_b32 v46, v41, v45, vcc
    v_cmp_eq_u32 vcc, 3, v91
    s_nop 1
    v_cndmask_b32 v47, v41, v45, vcc
    v_mov_b32 v45, 0
    v_cndmask_b32 v45, v41, v45, vcc
    v_fmamk_f32 v42, v37, 0x00000000, v40
    v_cos_f32 v43, v42
    v_sin_f32 v44, v42
    v_mul_f32 v43, v46, v43
    v_mul_f32 v44, v46, v44
    v_cvt_pk_bf16_f32 v64, v43, -v44
    v_fmamk_f32 v42, v37, 0x3f800000, v40
    v_cos_f32 v43, v42
    v_sin_f32 v44, v42
    v_mul_f32 v43, v41, v43
    v_mul_f32 v44, v41, v44
    v_cvt_pk_bf16_f32 v65, v43, -v44
    v_fmamk_f32 v42, v37, 0x40000000, v40
    v_cos_f32 v43, v42
    v_sin_f32 v44, v42
    v_mul_f32 v43, v41, v43
    v_mul_f32 v44, v41, v44
    v_cvt_pk_bf16_f32 v66, v43, -v44
    v_fmamk_f32 v42, v37, 0x40400000, v40
    v_cos_f32 v43, v42
    v_sin_f32 v44, v42
    v_mul_f32 v43, v41, v43
    v_mul_f32 v44, v41, v44
    v_cvt_pk_bf16_f32 v67, v43, -v44
    v_fmamk_f32 v42, v37, 0x41800000, v40
    v_cos_f32 v43, v42
    v_sin_f32 v44, v42
    v_mul_f32 v43, v47, v43
    v_mul_f32 v44, v47, v44
    v_cvt_pk_bf16_f32 v68, v43, -v44
    v_fmamk_f32 v42, v37, 0x41880000, v40
    v_cos_f32 v43, v42
    v_sin_f32 v44, v42
    v_mul_f32 v43, v45, v43
    v_mul_f32 v44, v45, v44
    v_cvt_pk_bf16_f32 v69, v43, -v44
    v_fmamk_f32 v42, v37, 0x41900000, v40
    v_cos_f32 v43, v42
    v_sin_f32 v44, v42
    v_mul_f32 v43, v45, v43
    v_mul_f32 v44, v45, v44
    v_cvt_pk_bf16_f32 v70, v43, -v44
    v_fmamk_f32 v42, v37, 0x41980000, v40
    v_cos_f32 v43, v42
    v_sin_f32 v44, v42
    v_mul_f32 v43, v45, v43
    v_mul_f32 v44, v45, v44
    v_cvt_pk_bf16_f32 v71, v43, -v44
    v_mul_u32_u24 v4, 160, v2
    v_lshl_add_u32 v4, v3, 2, v4
    v_add_u32 v4, 119936, v4
    v_lshrrev_b32 v5, 3, v90
    v_mul_u32_u24 v46, 5120, v5
    v_mul_u32_u24 v47, 160, v2
    v_add_u32 v46, v46, v47
    v_lshl_add_u32 v46, v91, 4, v46
    v_add_u32 v89, 119936, v46
    s_waitcnt lgkmcnt(0)
    v_bfe_u32 v95, v0, 2, 2
    v_and_b32 v96, 3, v0
    v_lshrrev_b32 v97, 1, v96
    v_and_b32 v96, 1, v96
    v_lshlrev_b32 v95, 4, v95
    v_lshl_add_u32 v95, v97, 6, v95
    v_lshl_add_u32 v95, v96, 3, v95
    v_lshl_add_u32 v95, v91, 7, v95
    s_lshl_b32 s26, s4, 11
    s_add_u32 s26, s26, 137472
    v_add_u32 v95, s26, v95
    v_mul_u32_u24 v96, 912, v2
    v_lshl_add_u32 v96, v91, 4, v96
    v_lshl_add_u32 v96, v5, 3, v96
    s_lshl_b32 s26, s4, 8
    s_add_u32 s26, s26, 130176
    v_add_u32 v96, s26, v96
    s_mov_b32 s59, 0
Lw30:
    ds_read_b32 v124, v127 offset:104
    s_waitcnt lgkmcnt(0)
    v_readfirstlane_b32 s58, v124
    s_nop 3
    s_cmp_ge_u32 s58, 1
    s_cbranch_scc1 Le31
    s_add_u32 s59, s59, 1
    s_cmp_gt_u32 s59, 2097152
    s_cbranch_scc1 Le31
    s_sleep 1
    s_branch Lw30
Le31:
    s_cmp_lt_u32 s2, 232
    s_cbranch_scc1 gated_mix__ssm_conv_s4__spectral_gfnet__prompt_kernel_p3_go
    s_and_b32 s26, s2, 7
    s_cmp_eq_u32 s26, 7
    s_cbranch_scc1 gated_mix__ssm_conv_s4__spectral_gfnet__prompt_kernel_p3_go
    s_mov_b32 s59, 0
Lw32:
    ds_read_b32 v124, v127 offset:108
    s_waitcnt lgkmcnt(0)
    v_readfirstlane_b32 s58, v124
    s_nop 3
    s_cmp_ge_u32 s58, 4
    s_cbranch_scc1 Le33
    s_add_u32 s59, s59, 1
    s_cmp_gt_u32 s59, 2097152
    s_cbranch_scc1 Le33
    s_sleep 4
    s_branch Lw32
Le33:
gated_mix__ssm_conv_s4__spectral_gfnet__prompt_kernel_p3_go:
    s_sleep 4
    s_mov_b32 s36, 0
    s_mov_b32 s37, 262144
    s_mov_b32 s38, 524288
    s_mov_b32 s39, 786432
    s_mov_b32 s40, 1048576
    s_mov_b32 s41, 1310720
    s_mov_b32 s42, 1572864
    s_mov_b32 s43, 1835008
    global_load_dword v7, v93, s[24:25] sc1
    s_mov_b32 s59, 0
Ld34:
    buffer_load_dword v8, v92, s[12:15], s36 offen sc1
    buffer_load_dword v9, v92, s[12:15], s37 offen sc1
    buffer_load_dword v10, v92, s[12:15], s38 offen sc1
    buffer_load_dword v11, v92, s[12:15], s39 offen sc1
    buffer_load_dword v12, v92, s[12:15], s40 offen sc1
    buffer_load_dword v13, v92, s[12:15], s41 offen sc1
    buffer_load_dword v14, v92, s[12:15], s42 offen sc1
    buffer_load_dword v15, v92, s[12:15], s43 offen sc1
    s_waitcnt vmcnt(0)
    v_max3_u32 v94, v8, v9, v10
    v_max3_u32 v94, v94, v11, v12
    v_max3_u32 v94, v94, v13, v14
    v_max_u32 v94, v94, v15
    v_cmp_eq_u32 vcc, -1, v94
    s_nop 3
    s_cmp_eq_u64 vcc, 0
    s_cbranch_scc1 Lf35
    s_mov_b64 exec, vcc
    s_add_u32 s59, s59, 1
    s_cmp_gt_u32 s59, 131072
    s_cbranch_scc1 Lf35
    s_sleep 8
    s_branch Ld34
Lf35:
    s_mov_b64 exec, -1
    v_lshlrev_b32 v72, 16, v8
    v_and_b32 v80, 0xffff0000, v8
    v_lshlrev_b32 v73, 16, v9
    v_and_b32 v81, 0xffff0000, v9
    v_lshlrev_b32 v74, 16, v10
    v_and_b32 v82, 0xffff0000, v10
    v_lshlrev_b32 v75, 16, v11
    v_and_b32 v83, 0xffff0000, v11
    v_lshlrev_b32 v76, 16, v12
    v_and_b32 v84, 0xffff0000, v12
    v_lshlrev_b32 v77, 16, v13
    v_and_b32 v85, 0xffff0000, v13
    v_lshlrev_b32 v78, 16, v14
    v_and_b32 v86, 0xffff0000, v14
    v_lshlrev_b32 v79, 16, v15
    v_and_b32 v87, 0xffff0000, v15
    v_pk_add_f32 v[48:49], v[72:73], v[76:77]
    v_pk_add_f32 v[50:51], v[74:75], v[78:79]
    v_pk_add_f32 v[52:53], v[80:81], v[84:85]
    v_pk_add_f32 v[54:55], v[82:83], v[86:87]
    v_pk_add_f32 v[56:57], v[72:73], v[76:77] neg_lo:[0,1] neg_hi:[0,1]
    v_pk_add_f32 v[58:59], v[80:81], v[84:85] neg_lo:[0,1] neg_hi:[0,1]
    v_sub_f32 v72, v75, v79
    v_sub_f32 v73, v83, v87
    v_sub_f32 v60, v86, v82
    v_sub_f32 v62, v74, v78
    v_add_f32 v80, v72, v73
    v_sub_f32 v81, v72, v73
    v_mul_f32 v61, 0xbf3504f3, v80
    v_mul_f32 v63, 0x3f3504f3, v81
    v_sub_f32 v80, v57, v59
    v_add_f32 v81, v57, v59
    v_mul_f32 v57, 0x3f3504f3, v80
    v_mul_f32 v59, 0x3f3504f3, v81
    v_pk_add_f32 v[74:75], v[48:49], v[50:51]
    v_pk_add_f32 v[76:77], v[48:49], v[50:51] neg_lo:[0,1] neg_hi:[0,1]
    v_pk_add_f32 v[78:79], v[52:53], v[54:55]
    v_pk_add_f32 v[82:83], v[52:53], v[54:55] neg_lo:[0,1] neg_hi:[0,1]
    v_pk_add_f32 v[48:49], v[74:75], v[74:75] op_sel:[0,1] op_sel_hi:[0,1] neg_hi:[0,1]
    v_pk_add_f32 v[52:53], v[78:79], v[78:79] op_sel:[0,1] op_sel_hi:[0,1] neg_hi:[0,1]
    v_pk_add_f32 v[50:51], v[76:77], v[82:83] op_sel:[0,1] op_sel_hi:[0,1] neg_lo:[0,1]
    v_pk_add_f32 v[54:55], v[82:83], v[76:77] op_sel:[0,1] op_sel_hi:[0,1] neg_hi:[0,1]
    v_pk_add_f32 v[74:75], v[56:57], v[60:61]
    v_pk_add_f32 v[76:77], v[56:57], v[60:61] neg_lo:[0,1] neg_hi:[0,1]
    v_pk_add_f32 v[78:79], v[58:59], v[62:63]
    v_pk_add_f32 v[82:83], v[58:59], v[62:63] neg_lo:[0,1] neg_hi:[0,1]
    v_pk_add_f32 v[56:57], v[74:75], v[74:75] op_sel:[0,1] op_sel_hi:[0,1] neg_hi:[0,1]
    v_pk_add_f32 v[58:59], v[78:79], v[78:79] op_sel:[0,1] op_sel_hi:[0,1] neg_hi:[0,1]
    v_pk_add_f32 v[60:61], v[76:77], v[82:83] op_sel:[0,1] op_sel_hi:[0,1] neg_lo:[0,1]
    v_pk_add_f32 v[62:63], v[82:83], v[76:77] op_sel:[0,1] op_sel_hi:[0,1] neg_hi:[0,1]
    v_pk_mul_f32 v[32:33], v[52:53], v[24:25]
    v_pk_mul_f32 v[34:35], v[48:49], v[24:25]
    v_pk_fma_f32 v[48:49], v[48:49], v[16:17], v[32:33] neg_lo:[0,0,1] neg_hi:[0,0,1]
    v_pk_fma_f32 v[52:53], v[52:53], v[16:17], v[34:35]
    v_pk_mul_f32 v[32:33], v[54:55], v[26:27]
    v_pk_mul_f32 v[34:35], v[50:51], v[26:27]
    v_pk_fma_f32 v[50:51], v[50:51], v[18:19], v[32:33] neg_lo:[0,0,1] neg_hi:[0,0,1]
    v_pk_fma_f32 v[54:55], v[54:55], v[18:19], v[34:35]
    v_pk_mul_f32 v[32:33], v[58:59], v[28:29]
    v_pk_mul_f32 v[34:35], v[56:57], v[28:29]
    v_pk_fma_f32 v[56:57], v[56:57], v[20:21], v[32:33] neg_lo:[0,0,1] neg_hi:[0,0,1]
    v_pk_fma_f32 v[58:59], v[58:59], v[20:21], v[34:35]
    v_pk_mul_f32 v[32:33], v[62:63], v[30:31]
    v_pk_mul_f32 v[34:35], v[60:61], v[30:31]
    v_pk_fma_f32 v[60:61], v[60:61], v[22:23], v[32:33] neg_lo:[0,0,1] neg_hi:[0,0,1]
    v_pk_fma_f32 v[62:63], v[62:63], v[22:23], v[34:35]
    v_cvt_pk_bf16_f32 v8, v48, v52
    ds_write_b32 v4, v8 offset:0
    v_cvt_pk_bf16_f32 v9, v56, v58
    ds_write_b32 v4, v9 offset:1280
    v_cvt_pk_bf16_f32 v10, v50, v54
    ds_write_b32 v4, v10 offset:2560
    v_cvt_pk_bf16_f32 v11, v60, v62
    ds_write_b32 v4, v11 offset:3840
    v_cvt_pk_bf16_f32 v12, v49, v53
    ds_write_b32 v4, v12 offset:5120
    v_cvt_pk_bf16_f32 v13, v57, v59
    ds_write_b32 v4, v13 offset:6400
    v_cvt_pk_bf16_f32 v14, v51, v55
    ds_write_b32 v4, v14 offset:7680
    v_cvt_pk_bf16_f32 v15, v61, v63
    ds_write_b32 v4, v15 offset:8960
    v_sub_f32 v18, 1.0, v7
    v_cvt_pk_bf16_f32 v18, v18, v18
    v_lshlrev_b32 v18, 16, v18
    s_waitcnt lgkmcnt(0)
    s_mov_b64 exec, 1
    ds_add_u32 v127, v126 offset:72
    s_mov_b64 exec, -1
    s_mov_b32 s59, 0
Lw36:
    ds_read_b32 v124, v127 offset:72
    s_waitcnt lgkmcnt(0)
    v_readfirstlane_b32 s58, v124
    s_nop 3
    s_cmp_ge_u32 s58, 4
    s_cbranch_scc1 Le37
    s_add_u32 s59, s59, 1
    s_cmp_gt_u32 s59, 2097152
    s_cbranch_scc1 Le37
    s_sleep 1
    s_branch Lw36
Le37:
    ds_read_b128 v[48:51], v89 offset:0
    ds_read_b128 v[52:55], v89 offset:64
    ds_read_b128 v[56:59], v89 offset:1280
    ds_read_b128 v[60:63], v89 offset:1344
    s_waitcnt lgkmcnt(3)
    v_mfma_f32_16x16x32_bf16 v[32:35], v[64:67], v[48:51], 0
    ds_read_b128 v[72:75], v89 offset:2560
    s_waitcnt lgkmcnt(3)
    v_mfma_f32_16x16x32_bf16 v[32:35], v[68:71], v[52:55], v[32:35]
    ds_read_b128 v[76:79], v89 offset:2624
    s_waitcnt lgkmcnt(3)
    v_mfma_f32_16x16x32_bf16 v[36:39], v[64:67], v[56:59], 0
    ds_read_b128 v[80:83], v89 offset:3840
    s_waitcnt lgkmcnt(3)
    v_mfma_f32_16x16x32_bf16 v[36:39], v[68:71], v[60:63], v[36:39]
    ds_read_b128 v[84:87], v89 offset:3904
    s_waitcnt lgkmcnt(3)
    v_mfma_f32_16x16x32_bf16 v[40:43], v[64:67], v[72:75], 0
    s_waitcnt lgkmcnt(2)
    v_mfma_f32_16x16x32_bf16 v[40:43], v[68:71], v[76:79], v[40:43]
    s_waitcnt lgkmcnt(1)
    v_mfma_f32_16x16x32_bf16 v[44:47], v[64:67], v[80:83], 0
    s_waitcnt lgkmcnt(0)
    v_mfma_f32_16x16x32_bf16 v[44:47], v[68:71], v[84:87], v[44:47]
    s_mov_b32 s59, 0
Lw38:
    ds_read_b32 v124, v127 offset:32
    s_waitcnt lgkmcnt(0)
    v_readfirstlane_b32 s58, v124
    s_nop 3
    s_cmp_ge_u32 s58, 4
    s_cbranch_scc1 Le39
    s_add_u32 s59, s59, 1
    s_cmp_gt_u32 s59, 2097152
    s_cbranch_scc1 Le39
    s_sleep 1
    s_branch Lw38
Le39:
    ds_read_b64_tr_b16 v[8:9], v95 offset:0
    ds_read_b64_tr_b16 v[10:11], v95 offset:512
    ds_read_b64_tr_b16 v[12:13], v95 offset:1024
    ds_read_b64_tr_b16 v[14:15], v95 offset:1536
    s_waitcnt lgkmcnt(0)
    v_lshlrev_b32 v20, 16, v8
    v_and_b32 v21, 0xffff0000, v8
    v_lshlrev_b32 v22, 16, v9
    v_and_b32 v23, 0xffff0000, v9
    v_mul_f32 v24, v18, v32
    v_mul_f32 v25, v18, v36
    v_mul_f32 v26, v18, v40
    v_mul_f32 v27, v18, v44
    v_fmac_f32 v24, v7, v20
    v_fmac_f32 v25, v7, v21
    v_fmac_f32 v26, v7, v22
    v_fmac_f32 v27, v7, v23
    v_cvt_pk_bf16_f32 v28, v24, v25
    v_cvt_pk_bf16_f32 v29, v26, v27
    ds_write_b64 v96, v[28:29] offset:0
    v_lshlrev_b32 v20, 16, v10
    v_and_b32 v21, 0xffff0000, v10
    v_lshlrev_b32 v22, 16, v11
    v_and_b32 v23, 0xffff0000, v11
    v_mul_f32 v24, v18, v33
    v_mul_f32 v25, v18, v37
    v_mul_f32 v26, v18, v41
    v_mul_f32 v27, v18, v45
    v_fmac_f32 v24, v7, v20
    v_fmac_f32 v25, v7, v21
    v_fmac_f32 v26, v7, v22
    v_fmac_f32 v27, v7, v23
    v_cvt_pk_bf16_f32 v30, v24, v25
    v_cvt_pk_bf16_f32 v31, v26, v27
    ds_write_b64 v96, v[30:31] offset:64
    s_cmp_eq_u32 s4, 3
    s_cbranch_scc1 gated_mix__ssm_conv_s4__spectral_gfnet__prompt_kernel_epi_done
    v_lshlrev_b32 v20, 16, v12
    v_and_b32 v21, 0xffff0000, v12
    v_lshlrev_b32 v22, 16, v13
    v_and_b32 v23, 0xffff0000, v13
    v_mul_f32 v24, v18, v34
    v_mul_f32 v25, v18, v38
    v_mul_f32 v26, v18, v42
    v_mul_f32 v27, v18, v46
    v_fmac_f32 v24, v7, v20
    v_fmac_f32 v25, v7, v21
    v_fmac_f32 v26, v7, v22
    v_fmac_f32 v27, v7, v23
    v_cvt_pk_bf16_f32 v28, v24, v25
    v_cvt_pk_bf16_f32 v29, v26, v27
    ds_write_b64 v96, v[28:29] offset:128
    v_lshlrev_b32 v20, 16, v14
    v_and_b32 v21, 0xffff0000, v14
    v_lshlrev_b32 v22, 16, v15
    v_and_b32 v23, 0xffff0000, v15
    v_mul_f32 v24, v18, v35
    v_mul_f32 v25, v18, v39
    v_mul_f32 v26, v18, v43
    v_mul_f32 v27, v18, v47
    v_fmac_f32 v24, v7, v20
    v_fmac_f32 v25, v7, v21
    v_fmac_f32 v26, v7, v22
    v_fmac_f32 v27, v7, v23
    v_cvt_pk_bf16_f32 v30, v24, v25
    v_cvt_pk_bf16_f32 v31, v26, v27
    ds_write_b64 v96, v[30:31] offset:192
gated_mix__ssm_conv_s4__spectral_gfnet__prompt_kernel_epi_done:
    v_add_u32 v2, 256, v88
    s_mov_b32 s26, 76695845
    v_mul_hi_u32 v3, v88, s26
    v_mul_hi_u32 v4, v2, s26
    v_mul_u32_u24 v5, 16, v3
    v_lshl_add_u32 v5, v88, 4, v5
    v_add_u32 v5, 130176, v5
    v_mul_u32_u24 v6, 16, v4
    v_lshl_add_u32 v6, v2, 4, v6
    v_add_u32 v6, 130176, v6
    s_mul_i32 s26, s5, 7168
    v_lshl_add_u32 v7, v88, 4, s26
    s_waitcnt lgkmcnt(0)
    s_mov_b64 exec, 1
    ds_add_u32 v127, v126 offset:76
    s_mov_b64 exec, -1
    s_mov_b32 s59, 0
Lw40:
    ds_read_b32 v124, v127 offset:76
    s_waitcnt lgkmcnt(0)
    v_readfirstlane_b32 s58, v124
    s_nop 3
    s_cmp_ge_u32 s58, 4
    s_cbranch_scc1 Le41
    s_add_u32 s59, s59, 1
    s_cmp_gt_u32 s59, 2097152
    s_cbranch_scc1 Le41
    s_sleep 1
    s_branch Lw40
Le41:
    ds_read_b128 v[8:11], v5
    v_cmp_gt_u32 vcc, 192, v88
    s_nop 3
    s_and_saveexec_b64 s[28:29], vcc
    s_cbranch_execz gated_mix__ssm_conv_s4__spectral_gfnet__prompt_kernel_one
    ds_read_b128 v[12:15], v6
    v_add_u32 v6, 4096, v7
    s_waitcnt lgkmcnt(0)
    global_store_dwordx4 v6, v[12:15], s[8:9]
gated_mix__ssm_conv_s4__spectral_gfnet__prompt_kernel_one:
    s_mov_b64 exec, s[28:29]
    s_waitcnt lgkmcnt(0)
    global_store_dwordx4 v7, v[8:11], s[8:9]
    s_endpgm
gated_mix__ssm_conv_s4__spectral_gfnet__prompt_kernel_T:
    s_load_dwordx2 s[8:9], s[0:1], 0
    s_load_dwordx4 s[16:19], s[0:1], 80
    s_sub_u32 s4, s3, 12
    s_and_b32 s5, s2, 7
    s_lshr_b32 s6, s2, 3
    s_cmp_lg_u32 s4, 0
    s_cbranch_scc1 gated_mix__ssm_conv_s4__spectral_gfnet__prompt_kernel_t_nz
    v_lshlrev_b32 v2, 2, v0
    ds_write_b32 v2, v127
gated_mix__ssm_conv_s4__spectral_gfnet__prompt_kernel_t_nz:
    s_mul_i32 s7, s4, 4608
    s_add_u32 s7, s7, 70528
    s_and_b32 s37, s2, 1
    s_lshr_b32 s38, s2, 1
    s_lshr_b32 s39, s38, 5
    s_bfe_u32 s40, s38, 0x20003
    s_and_b32 s41, s38, 7
    s_lshl_b32 s29, s41, 1
    s_lshl_b32 s30, s39, 4
    s_add_u32 s29, s29, s30
    s_lshl_b32 s30, s40, 8
    s_add_u32 s29, s29, s30
    s_lshl_b32 s42, s37, 2
    s_add_u32 s42, s42, s4
    s_mul_i32 s31, s42, 56
    v_and_b32 v24, 31, v0
    v_lshrrev_b32 v25, 5, v0
    v_lshlrev_b32 v26, 10, v25
    v_add_u32 v26, s29, v26
    s_cmp_eq_u32 s37, 0
    s_cbranch_scc1 gated_mix__ssm_conv_s4__spectral_gfnet__prompt_kernel_wdir
    v_sub_u32 v26, 2048, v26
    s_sub_u32 s31, 448, s31
    v_sub_u32 v27, s31, v24
    s_mov_b32 s33, -450
    s_mov_b32 s34, 0x80000000
    s_branch gated_mix__ssm_conv_s4__spectral_gfnet__prompt_kernel_wcom
gated_mix__ssm_conv_s4__spectral_gfnet__prompt_kernel_wdir:
    v_add_u32 v27, s31, v24
    s_mov_b32 s33, 450
    s_mov_b32 s34, 0
gated_mix__ssm_conv_s4__spectral_gfnet__prompt_kernel_wcom:
    s_movk_i32 s35, 450
    v_lshlrev_b32 v27, 1, v27
    v_mad_u32_u24 v28, v26, s35, v27
    v_and_b32 v26, 2047, v26
    v_mad_u32_u24 v29, v26, s35, v27
    s_waitcnt lgkmcnt(0)
    s_mov_b32 s12, s8
    s_and_b32 s13, s9, 0xffff
    s_mov_b32 s14, 1835008
    s_mov_b32 s15, 0x00020000
    s_cmp_eq_u32 s5, 7
    s_cbranch_scc1 gated_mix__ssm_conv_s4__spectral_gfnet__prompt_kernel_t_nox
    s_lshl_b32 s43, s5, 7
    s_lshl_b32 s44, s4, 5
    s_add_u32 s43, s43, s44
    s_lshl_b32 s44, s6, 6
    s_add_u32 s45, s44, 63
    v_lshrrev_b32 v2, 1, v0
    v_sub_u32 v2, s45, v2
    v_mul_u32_u24 v2, 896, v2
    v_and_b32 v3, 1, v0
    v_lshl_add_u32 v2, v3, 4, v2
    v_add_u32 v2, s43, v2
    s_mov_b32 m0, s7
    v_subrev_u32 v4, 28672, v2
    buffer_load_dwordx4 v2, s[12:15], 0 offen lds
    s_add_u32 m0, s7, 1024
    s_nop 0
    buffer_load_dwordx4 v4, s[12:15], 0 offen lds
gated_mix__ssm_conv_s4__spectral_gfnet__prompt_kernel_t_nox:
    global_load_ushort v32, v29, s[16:17]
    global_load_ushort v40, v29, s[18:19]
    s_mul_i32 s36, s33, 64
    v_add_u32 v30, s36, v28
    global_load_ushort v33, v30, s[16:17]
    global_load_ushort v41, v30, s[18:19]
    s_mul_i32 s36, s33, 128
    v_add_u32 v30, s36, v28
    global_load_ushort v34, v30, s[16:17]
    global_load_ushort v42, v30, s[18:19]
    s_mul_i32 s36, s33, 192
    v_add_u32 v30, s36, v28
    global_load_ushort v35, v30, s[16:17]
    global_load_ushort v43, v30, s[18:19]
    s_mul_i32 s36, s33, 1
    v_add_u32 v30, s36, v28
    global_load_ushort v36, v30, s[16:17]
    global_load_ushort v44, v30, s[18:19]
    s_mul_i32 s36, s33, 65
    v_add_u32 v30, s36, v28
    global_load_ushort v37, v30, s[16:17]
    global_load_ushort v45, v30, s[18:19]
    s_mul_i32 s36, s33, 129
    v_add_u32 v30, s36, v28
    global_load_ushort v38, v30, s[16:17]
    global_load_ushort v46, v30, s[18:19]
    s_mul_i32 s36, s33, 193
    v_add_u32 v30, s36, v28
    global_load_ushort v39, v30, s[16:17]
    global_load_ushort v47, v30, s[18:19]
    s_barrier
    s_setprio 2
    s_cmp_eq_u32 s5, 7
    s_cbranch_scc1 gated_mix__ssm_conv_s4__spectral_gfnet__prompt_kernel_w_only
    s_cmp_lg_u32 s4, 2
    s_cbranch_scc1 gated_mix__ssm_conv_s4__spectral_gfnet__prompt_kernel_t_nt
    v_mov_b32 v20, 0
    v_mov_b32 v21, 0
    v_mov_b32 v22, 0
    v_mov_b32 v23, 0
    v_lshrrev_b32 v5, 1, v0
    v_mul_u32_u24 v5, 4160, v5
    v_and_b32 v6, 1, v0
    v_lshl_add_u32 v5, v6, 4, v5
    v_add_u32 v5, 93056, v5
    s_mov_b64 exec, 0xff
    ds_write_b128 v5, v[20:23]
    s_mov_b64 exec, -1
gated_mix__ssm_conv_s4__spectral_gfnet__prompt_kernel_t_nt:
    v_lshrrev_b32 v8, 4, v0
    v_bfe_u32 v9, v0, 2, 2
    v_lshl_add_u32 v9, v8, 3, v9
    v_lshlrev_b32 v9, 5, v9
    v_and_b32 v10, 3, v0
    v_lshl_add_u32 v9, v10, 3, v9
    v_add_u32 v9, s7, v9
    v_and_b32 v10, 15, v0
    v_mul_u32_u24 v10, 144, v10
    v_lshl_add_u32 v10, v8, 4, v10
    s_add_u32 s45, s7, 2080
    v_add_u32 v10, s45, v10
    v_lshrrev_b32 v11, 3, v0
    v_and_b32 v12, 7, v0
    v_mul_u32_u24 v13, 144, v11
    v_lshl_add_u32 v13, v12, 4, v13
    v_add_u32 v13, s45, v13
    s_lshr_b32 s46, s43, 1
    v_add_u32 v11, s46, v11
    v_mul_u32_u24 v11, 4112, v11
    v_lshl_add_u32 v11, v12, 4, v11
    s_sub_u32 s47, 31, s6
    s_lshl_b32 s47, s47, 7
    v_add_u32 v11, s47, v11
    s_waitcnt vmcnt(16)
    ds_read_b64_tr_b16 v[64:65], v9 offset:0
    ds_read_b64_tr_b16 v[66:67], v9 offset:128
    ds_read_b64_tr_b16 v[68:69], v9 offset:1024
    ds_read_b64_tr_b16 v[70:71], v9 offset:1152
    s_waitcnt lgkmcnt(0)
    ds_write_b128 v10, v[64:67] offset:0
    ds_write_b128 v10, v[68:71] offset:64
    ds_read_b128 v[80:83], v13 offset:0
    ds_read_b128 v[84:87], v13 offset:1152
    s_add_u32 s48, s24, 4194304
    s_addc_u32 s49, s25, 0
    v_add_u32 v14, 32896, v11
    s_waitcnt lgkmcnt(1)
    global_store_dwordx4 v11, v[80:83], s[48:49] sc1
    s_waitcnt lgkmcnt(0)
    global_store_dwordx4 v14, v[84:87], s[48:49] sc1
    s_cmp_lg_u32 s6, 0
    s_cbranch_scc1 gated_mix__ssm_conv_s4__spectral_gfnet__prompt_kernel_wpack4
    v_and_b32 v14, 15, v0
    v_add_u32 v14, s46, v14
    v_mul_u32_u24 v14, 4112, v14
    v_add_u32 v14, 4198400, v14
    v_mov_b32 v96, 0
    v_mov_b32 v97, 0
    v_mov_b32 v98, 0
    v_mov_b32 v99, 0
    s_mov_b64 exec, 0xffff
    global_store_dwordx4 v14, v[96:99], s[24:25] sc1
    s_mov_b64 exec, -1
    s_waitcnt vmcnt(3)
    s_branch gated_mix__ssm_conv_s4__spectral_gfnet__prompt_kernel_wpack
gated_mix__ssm_conv_s4__spectral_gfnet__prompt_kernel_wpack4:
    s_waitcnt vmcnt(2)
    s_branch gated_mix__ssm_conv_s4__spectral_gfnet__prompt_kernel_wpack
gated_mix__ssm_conv_s4__spectral_gfnet__prompt_kernel_w_only:
    s_waitcnt vmcnt(0)
gated_mix__ssm_conv_s4__spectral_gfnet__prompt_kernel_wpack:
    v_lshl_or_b32 v48, v40, 16, v32
    v_xor_b32 v48, s34, v48
    v_lshl_or_b32 v49, v41, 16, v33
    v_xor_b32 v49, s34, v49
    v_lshl_or_b32 v50, v42, 16, v34
    v_xor_b32 v50, s34, v50
    v_lshl_or_b32 v51, v43, 16, v35
    v_xor_b32 v51, s34, v51
    v_lshl_or_b32 v52, v44, 16, v36
    v_xor_b32 v52, s34, v52
    v_lshl_or_b32 v53, v45, 16, v37
    v_xor_b32 v53, s34, v53
    v_lshl_or_b32 v54, v46, 16, v38
    v_xor_b32 v54, s34, v54
    v_lshl_or_b32 v55, v47, 16, v39
    v_xor_b32 v55, s34, v55
    v_mul_u32_u24 v24, 80, v24
    v_lshl_add_u32 v24, v25, 5, v24
    v_add_u32 v24, s7, v24
    ds_write_b128 v24, v[48:51]
    ds_write_b128 v24, v[52:55] offset:16
    v_lshrrev_b32 v26, 2, v0
    v_and_b32 v27, 3, v0
    v_mul_u32_u24 v28, 80, v26
    v_lshl_add_u32 v28, v27, 4, v28
    v_add_u32 v28, s7, v28
    ds_read_b128 v[56:59], v28
    ds_read_b128 v[60:63], v28 offset:1280
    s_lshl_b32 s36, s42, 18
    s_lshl_b32 s29, s39, 11
    s_add_u32 s36, s36, s29
    s_lshl_b32 s29, s40, 9
    s_add_u32 s36, s36, s29
    s_lshl_b32 s29, s41, 6
    s_add_u32 s36, s36, s29
    s_add_u32 s36, s36, 2097152
    v_lshlrev_b32 v26, 13, v26
    v_lshl_add_u32 v26, v27, 4, v26
    v_add_u32 v26, s36, v26
    v_add_u32 v27, 131072, v26
    s_waitcnt lgkmcnt(1)
    global_store_dwordx4 v26, v[56:59], s[24:25] sc1
    s_waitcnt lgkmcnt(0)
    s_mov_b32 exec_hi, 0x000fffff
    global_store_dwordx4 v27, v[60:63], s[24:25] sc1
    s_mov_b64 exec, -1
    s_cmp_eq_u32 s5, 7
    s_cbranch_scc1 gated_mix__ssm_conv_s4__spectral_gfnet__prompt_kernel_t_no0
    s_waitcnt vmcnt(2)
    s_mov_b64 exec, 1
    ds_add_rtn_u32 v124, v127, v126 offset:92
    s_waitcnt lgkmcnt(0)
    v_readfirstlane_b32 s58, v124
    s_mov_b64 exec, -1
    s_nop 2
    s_cmp_eq_u32 s58, 3
    s_cbranch_scc0 Ln42
    s_mov_b32 s59, 0
Lk43:
    ds_read_b32 v124, v127 offset:80
    s_waitcnt lgkmcnt(0)
    v_readfirstlane_b32 s57, v124
    s_nop 3
    s_cmp_lg_u32 s57, 0
    s_cbranch_scc1 Ll44
    s_add_u32 s59, s59, 1
    s_cmp_gt_u32 s59, 2097152
    s_cbranch_scc1 Ll44
    s_sleep 1
    s_branch Lk43
Ll44:
    s_lshl_b32 s58, s2, 6
    s_add_u32 s58, s58, 16121856
    v_mbcnt_lo_u32_b32 v124, -1, 0
    v_mul_u32_u24 v124, 16384, v124
    v_add_u32 v124, s58, v124
    v_mov_b32 v125, s57
    s_mov_b64 exec, 1
    global_store_dword v124, v125, s[24:25] sc1
    s_mov_b64 exec, -1
    s_waitcnt vmcnt(1)
    s_branch gated_mix__ssm_conv_s4__spectral_gfnet__prompt_kernel_t_dr
Ln42:
gated_mix__ssm_conv_s4__spectral_gfnet__prompt_kernel_t_no0:
    s_waitcnt vmcnt(0)
gated_mix__ssm_conv_s4__spectral_gfnet__prompt_kernel_t_dr:
    s_mov_b64 exec, 1
    ds_add_rtn_u32 v124, v127, v126 offset:0
    s_waitcnt lgkmcnt(0)
    v_readfirstlane_b32 s58, v124
    s_mov_b64 exec, -1
    s_nop 2
    s_cmp_eq_u32 s58, 7
    s_cbranch_scc0 Ln45
    s_mov_b32 s59, 0
Lk46:
    ds_read_b32 v124, v127 offset:80
    s_waitcnt lgkmcnt(0)
    v_readfirstlane_b32 s57, v124
    s_nop 3
    s_cmp_lg_u32 s57, 0
    s_cbranch_scc1 Ll47
    s_add_u32 s59, s59, 1
    s_cmp_gt_u32 s59, 2097152
    s_cbranch_scc1 Ll47
    s_sleep 1
    s_branch Lk46
Ll47:
    s_lshl_b32 s58, s2, 6
    s_add_u32 s58, s58, 15728640
    v_mbcnt_lo_u32_b32 v124, -1, 0
    v_mul_u32_u24 v124, 16384, v124
    v_add_u32 v124, s58, v124
    v_mov_b32 v125, s57
    s_mov_b64 exec, 1
    global_store_dword v124, v125, s[24:25] sc1
    s_mov_b64 exec, -1
Ln45:
    s_setprio 0
    s_mov_b32 s12, s24
    s_and_b32 s13, s25, 0xffff
    s_mov_b32 s14, 16777216
    s_mov_b32 s15, 0x00020000
    s_cmp_lt_u32 s4, 2
    s_cbranch_scc1 gated_mix__ssm_conv_s4__spectral_gfnet__prompt_kernel_t_ncl
    s_mov_b32 s59, 0
Lw48:
    ds_read_b32 v124, v127 offset:0
    s_waitcnt lgkmcnt(0)
    v_readfirstlane_b32 s58, v124
    s_nop 3
    s_cmp_ge_u32 s58, 8
    s_cbranch_scc1 Le49
    s_add_u32 s59, s59, 1
    s_cmp_gt_u32 s59, 2097152
    s_cbranch_scc1 Le49
    s_sleep 2
    s_branch Lw48
Le49:
    v_mov_b32 v8, -1
    v_mov_b32 v9, -1
    v_mov_b32 v10, -1
    v_mov_b32 v11, -1
    s_sub_u32 s26, s4, 2
    s_lshl_b32 s26, s26, 12
    v_lshl_add_u32 v12, v0, 4, s26
    s_mov_b32 s36, 0x7ff00000
    s_lshl_b32 s27, s5, 5
    s_add_u32 s27, s27, s6
    s_lshl_b32 s27, s27, 13
    s_add_u32 s27, s27, 11534336
    s_cmp_ge_u32 s2, 232
    s_cselect_b32 s27, s36, s27
    s_lshl_b32 s28, s5, 6
    s_lshl_b32 s29, s6, 1
    s_add_u32 s28, s28, s29
    s_lshl_b32 s28, s28, 12
    s_add_u32 s28, s28, 13631488
    s_cmp_eq_u32 s5, 7
    s_cselect_b32 s28, s36, s28
    buffer_store_dwordx4 v[8:11], v12, s[12:15], s27 offen offset:0 sc1
    buffer_store_dwordx4 v[8:11], v12, s[12:15], s27 offen offset:1024 sc1
    buffer_store_dwordx4 v[8:11], v12, s[12:15], s27 offen offset:2048 sc1
    buffer_store_dwordx4 v[8:11], v12, s[12:15], s27 offen offset:3072 sc1
    buffer_store_dwordx4 v[8:11], v12, s[12:15], s28 offen offset:0 sc1
    buffer_store_dwordx4 v[8:11], v12, s[12:15], s28 offen offset:1024 sc1
    buffer_store_dwordx4 v[8:11], v12, s[12:15], s28 offen offset:2048 sc1
    buffer_store_dwordx4 v[8:11], v12, s[12:15], s28 offen offset:3072 sc1
    s_waitcnt vmcnt(0)
    s_mov_b64 exec, 1
    ds_add_rtn_u32 v124, v127, v126 offset:100
    s_waitcnt lgkmcnt(0)
    v_readfirstlane_b32 s58, v124
    s_mov_b64 exec, -1
    s_nop 2
    s_cmp_eq_u32 s58, 1
    s_cbranch_scc0 Ln50
    s_mov_b32 s59, 0
Lk51:
    ds_read_b32 v124, v127 offset:80
    s_waitcnt lgkmcnt(0)
    v_readfirstlane_b32 s57, v124
    s_nop 3
    s_cmp_lg_u32 s57, 0
    s_cbranch_scc1 Ll52
    s_add_u32 s59, s59, 1
    s_cmp_gt_u32 s59, 2097152
    s_cbranch_scc1 Ll52
    s_sleep 1
    s_branch Lk51
Ll52:
    s_lshl_b32 s58, s2, 6
    s_add_u32 s58, s58, 15859712
    v_mbcnt_lo_u32_b32 v124, -1, 0
    v_mul_u32_u24 v124, 16384, v124
    v_add_u32 v124, s58, v124
    v_mov_b32 v125, s57
    s_mov_b64 exec, 1
    global_store_dword v124, v125, s[24:25] sc1
    s_mov_b64 exec, -1
Ln50:
gated_mix__ssm_conv_s4__spectral_gfnet__prompt_kernel_t_ncl:
    s_cmp_lg_u32 s4, 1
    s_cbranch_scc1 gated_mix__ssm_conv_s4__spectral_gfnet__prompt_kernel_t_n0
    s_cmp_eq_u32 s5, 7
    s_cbranch_scc1 gated_mix__ssm_conv_s4__spectral_gfnet__prompt_kernel_t_n0
    s_mov_b32 s59, 0
Lw53:
    ds_read_b32 v124, v127 offset:92
    s_waitcnt lgkmcnt(0)
    v_readfirstlane_b32 s58, v124
    s_nop 3
    s_cmp_ge_u32 s58, 4
    s_cbranch_scc1 Le54
    s_add_u32 s59, s59, 1
    s_cmp_gt_u32 s59, 2097152
    s_cbranch_scc1 Le54
    s_sleep 2
    s_branch Lw53
Le54:
    s_mov_b32 s59, 0
Lk55:
    ds_read_b32 v124, v127 offset:80
    s_waitcnt lgkmcnt(0)
    v_readfirstlane_b32 s57, v124
    s_nop 3
    s_cmp_lg_u32 s57, 0
    s_cbranch_scc1 Ll56
    s_add_u32 s59, s59, 1
    s_cmp_gt_u32 s59, 2097152
    s_cbranch_scc1 Ll56
    s_sleep 1
    s_branch Lk55
Ll56:
    s_sleep 8
    v_mbcnt_lo_u32_b32 v110, -1, 0
    v_mbcnt_hi_u32_b32 v110, -1, v110
    v_lshlrev_b32 v111, 3, v110
    v_add_u32 v111, s5, v111
    v_lshlrev_b32 v111, 6, v111
    v_add_u32 v111, 16121856, v111
    s_lshr_b32 s58, s2, 3
    s_and_b32 s58, s58, 0
    s_mul_i32 s58, s58, 16384
    v_add_u32 v111, s58, v111
    s_mov_b32 exec_hi, 0
    s_mov_b32 s59, 0
Lp57:
    global_load_dword v116, v111, s[24:25] sc1
    s_waitcnt vmcnt(0)
    v_cmp_ne_u32 vcc, s57, v116
    s_nop 3
    s_cmp_eq_u64 vcc, 0
    s_cbranch_scc1 Lq58
    s_mov_b64 exec, vcc
    s_add_u32 s59, s59, 1
    s_cmp_gt_u32 s59, 131072
    s_cbranch_scc1 Lq58
    s_sleep 2
    s_branch Lp57
Lq58:
    s_mov_b64 exec, -1
    s_mov_b64 exec, 1
    ds_add_u32 v127, v126 offset:96
    s_mov_b64 exec, -1
gated_mix__ssm_conv_s4__spectral_gfnet__prompt_kernel_t_n0:
    s_cmp_lg_u32 s4, 0
    s_cbranch_scc1 gated_mix__ssm_conv_s4__spectral_gfnet__prompt_kernel_t_w1
    s_mov_b32 s59, 0
Lw59:
    ds_read_b32 v124, v127 offset:0
    s_waitcnt lgkmcnt(0)
    v_readfirstlane_b32 s58, v124
    s_nop 3
    s_cmp_ge_u32 s58, 8
    s_cbranch_scc1 Le60
    s_add_u32 s59, s59, 1
    s_cmp_gt_u32 s59, 2097152
    s_cbranch_scc1 Le60
    s_sleep 2
    s_branch Lw59
Le60:
    s_mov_b32 s59, 0
Lk61:
    ds_read_b32 v124, v127 offset:80
    s_waitcnt lgkmcnt(0)
    v_readfirstlane_b32 s57, v124
    s_nop 3
    s_cmp_lg_u32 s57, 0
    s_cbranch_scc1 Ll62
    s_add_u32 s59, s59, 1
    s_cmp_gt_u32 s59, 2097152
    s_cbranch_scc1 Ll62
    s_sleep 1
    s_branch Lk61
Ll62:
    s_cmp_eq_u32 s5, 7
    s_cbranch_scc1 gated_mix__ssm_conv_s4__spectral_gfnet__prompt_kernel_t_s1a
    s_mov_b32 s59, 0
Lw63:
    ds_read_b32 v124, v127 offset:96
    s_waitcnt lgkmcnt(0)
    v_readfirstlane_b32 s58, v124
    s_nop 3
    s_cmp_ge_u32 s58, 1
    s_cbranch_scc1 Le64
    s_add_u32 s59, s59, 1
    s_cmp_gt_u32 s59, 2097152
    s_cbranch_scc1 Le64
    s_sleep 1
    s_branch Lw63
Le64:
    s_branch gated_mix__ssm_conv_s4__spectral_gfnet__prompt_kernel_t_s1b
gated_mix__ssm_conv_s4__spectral_gfnet__prompt_kernel_t_s1a:
    s_sleep 36
gated_mix__ssm_conv_s4__spectral_gfnet__prompt_kernel_t_s1b:
    v_mbcnt_lo_u32_b32 v110, -1, 0
    v_mbcnt_hi_u32_b32 v110, -1, v110
    v_lshlrev_b32 v111, 6, v110
    v_add_u32 v111, 15728640, v111
    s_lshr_b32 s58, s2, 3
    s_and_b32 s58, s58, 0
    s_mul_i32 s58, s58, 16384
    v_add_u32 v111, s58, v111
    v_add_u32 v112, 4096, v111
    v_add_u32 v113, 8192, v111
    v_add_u32 v114, 12288, v111
    v_cmp_gt_u32 vcc, 64, v110
    s_nop 1
    v_cndmask_b32 v114, v111, v114, vcc
    s_mov_b32 s59, 0
Lp65:
    global_load_dword v116, v111, s[24:25] sc1
    global_load_dword v117, v112, s[24:25] sc1
    global_load_dword v118, v113, s[24:25] sc1
    global_load_dword v119, v114, s[24:25] sc1
    s_waitcnt vmcnt(0)
    v_xor_b32 v116, s57, v116
    v_xor_b32 v117, s57, v117
    v_xor_b32 v118, s57, v118
    v_xor_b32 v119, s57, v119
    v_or_b32 v116, v116, v117
    v_or_b32 v118, v118, v119
    v_or_b32 v116, v116, v118
    v_cmp_ne_u32 vcc, 0, v116
    s_nop 3
    s_cmp_eq_u64 vcc, 0
    s_cbranch_scc1 Lq66
    s_mov_b64 exec, vcc
    s_add_u32 s59, s59, 1
    s_cmp_gt_u32 s59, 131072
    s_cbranch_scc1 Lq66
    s_sleep 4
    s_branch Lp65
Lq66:
    s_mov_b64 exec, -1
    s_mov_b64 exec, 1
    ds_add_u32 v127, v126 offset:12
    s_mov_b64 exec, -1
    s_cmp_ge_u32 s2, 232
    s_cbranch_scc1 gated_mix__ssm_conv_s4__spectral_gfnet__prompt_kernel_t_w1
    s_lshr_b32 s26, s6, 4
    s_lshl_b32 s26, s26, 7
    s_lshl_b32 s27, s5, 4
    s_add_u32 s26, s26, s27
    s_and_b32 s27, s6, 15
    s_add_u32 s26, s26, s27
    s_lshl_b32 s26, s26, 4
    s_add_u32 s26, s26, 0
    v_lshrrev_b32 v2, 5, v0
    v_lshlrev_b32 v2, 2, v2
    v_xor_b32 v2, v2, v0
    v_lshlrev_b32 v2, 12, v2
    s_add_u32 s31, s26, 0
    s_mov_b32 m0, 70528
    s_nop 0
    buffer_load_dwordx4 v2, s[12:15], s31 offen sc1 lds
    s_add_u32 s31, s26, 262144
    s_mov_b32 m0, 71552
    s_nop 0
    buffer_load_dwordx4 v2, s[12:15], s31 offen sc1 lds
    s_add_u32 s31, s26, 524288
    s_mov_b32 m0, 72576
    s_nop 0
    buffer_load_dwordx4 v2, s[12:15], s31 offen sc1 lds
    s_add_u32 s31, s26, 786432
    s_mov_b32 m0, 73600
    s_nop 0
    buffer_load_dwordx4 v2, s[12:15], s31 offen sc1 lds
    s_add_u32 s31, s26, 1048576
    s_mov_b32 m0, 74624
    s_nop 0
    buffer_load_dwordx4 v2, s[12:15], s31 offen sc1 lds
    s_add_u32 s31, s26, 1310720
    s_mov_b32 m0, 75648
    s_nop 0
    buffer_load_dwordx4 v2, s[12:15], s31 offen sc1 lds
    s_add_u32 s31, s26, 1572864
    s_mov_b32 m0, 76672
    s_nop 0
    buffer_load_dwordx4 v2, s[12:15], s31 offen sc1 lds
    s_add_u32 s31, s26, 1835008
    s_mov_b32 m0, 77696
    s_nop 0
    buffer_load_dwordx4 v2, s[12:15], s31 offen sc1 lds
    s_waitcnt vmcnt(0)
    s_mov_b64 exec, 1
    ds_add_u32 v127, v126 offset:24
    s_mov_b64 exec, -1
gated_mix__ssm_conv_s4__spectral_gfnet__prompt_kernel_t_w1:
    s_cmp_lg_u32 s4, 0
    s_cbranch_scc1 gated_mix__ssm_conv_s4__spectral_gfnet__prompt_kernel_t_wc
    v_mbcnt_lo_u32_b32 v110, -1, 0
    v_mbcnt_hi_u32_b32 v110, -1, v110
    v_lshlrev_b32 v111, 6, v110
    v_add_u32 v111, 15859712, v111
    s_lshr_b32 s58, s2, 3
    s_and_b32 s58, s58, 0
    s_mul_i32 s58, s58, 16384
    v_add_u32 v111, s58, v111
    v_add_u32 v112, 4096, v111
    v_add_u32 v113, 8192, v111
    v_add_u32 v114, 12288, v111
    v_cmp_gt_u32 vcc, 64, v110
    s_nop 1
    v_cndmask_b32 v114, v111, v114, vcc
    s_mov_b32 s59, 0
Lp67:
    global_load_dword v116, v111, s[24:25] sc1
    global_load_dword v117, v112, s[24:25] sc1
    global_load_dword v118, v113, s[24:25] sc1
    global_load_dword v119, v114, s[24:25] sc1
    s_waitcnt vmcnt(0)
    v_xor_b32 v116, s57, v116
    v_xor_b32 v117, s57, v117
    v_xor_b32 v118, s57, v118
    v_xor_b32 v119, s57, v119
    v_or_b32 v116, v116, v117
    v_or_b32 v118, v118, v119
    v_or_b32 v116, v116, v118
    v_cmp_ne_u32 vcc, 0, v116
    s_nop 3
    s_cmp_eq_u64 vcc, 0
    s_cbranch_scc1 Lq68
    s_mov_b64 exec, vcc
    s_add_u32 s59, s59, 1
    s_cmp_gt_u32 s59, 131072
    s_cbranch_scc1 Lq68
    s_sleep 4
    s_branch Lp67
Lq68:
    s_mov_b64 exec, -1
    s_mov_b64 exec, 1
    ds_add_u32 v127, v126 offset:104
    s_mov_b64 exec, -1
gated_mix__ssm_conv_s4__spectral_gfnet__prompt_kernel_t_wc:
    s_mov_b32 s59, 0
Lw69:
    ds_read_b32 v124, v127 offset:104
    s_waitcnt lgkmcnt(0)
    v_readfirstlane_b32 s58, v124
    s_nop 3
    s_cmp_ge_u32 s58, 1
    s_cbranch_scc1 Le70
    s_add_u32 s59, s59, 1
    s_cmp_gt_u32 s59, 2097152
    s_cbranch_scc1 Le70
    s_sleep 2
    s_branch Lw69
Le70:
    s_cmp_eq_u32 s5, 7
    s_cbranch_scc1 gated_mix__ssm_conv_s4__spectral_gfnet__prompt_kernel_t_wz
    s_mov_b32 s59, 0
Lw71:
    ds_read_b32 v124, v127 offset:108
    s_waitcnt lgkmcnt(0)
    v_readfirstlane_b32 s58, v124
    s_nop 3
    s_cmp_ge_u32 s58, 4
    s_cbranch_scc1 Le72
    s_add_u32 s59, s59, 1
    s_cmp_gt_u32 s59, 2097152
    s_cbranch_scc1 Le72
    s_sleep 4
    s_branch Lw71
Le72:
    s_branch gated_mix__ssm_conv_s4__spectral_gfnet__prompt_kernel_t_wa
gated_mix__ssm_conv_s4__spectral_gfnet__prompt_kernel_t_wz:
    s_cmp_ge_u32 s2, 232
    s_cbranch_scc1 gated_mix__ssm_conv_s4__spectral_gfnet__prompt_kernel_t_wa
    s_mov_b32 s59, 0
Lw73:
    ds_read_b32 v124, v127 offset:116
    s_waitcnt lgkmcnt(0)
    v_readfirstlane_b32 s58, v124
    s_nop 3
    s_cmp_ge_u32 s58, 4
    s_cbranch_scc1 Le74
    s_add_u32 s59, s59, 1
    s_cmp_gt_u32 s59, 2097152
    s_cbranch_scc1 Le74
    s_sleep 4
    s_branch Lw73
Le74:
gated_mix__ssm_conv_s4__spectral_gfnet__prompt_kernel_t_wa:
    s_sleep 28
    s_lshl_b32 s5, s5, 5
    s_add_u32 s5, s5, s6
    v_lshlrev_b32 v5, 12, v0
    s_lshl_b32 s26, s5, 4
    s_add_u32 s26, s26, 13631488
    s_lshl_b32 s27, s4, 18
    s_add_u32 s27, s27, s26
    v_add_u32 v5, s27, v5
    v_add_u32 v6, 1048576, v5
    s_lshl_b32 s28, s4, 10
    s_add_u32 s28, s28, 137472
    v_lshl_add_u32 v7, v0, 4, s28
    s_cmp_eq_u32 s4, 3
    s_cbranch_scc1 gated_mix__ssm_conv_s4__spectral_gfnet__prompt_kernel_t_a1
    s_mov_b32 s59, 0
Ld75:
    global_load_dwordx4 v[8:11], v5, s[24:25] sc1
    global_load_dwordx4 v[12:15], v6, s[24:25] sc1
    s_waitcnt vmcnt(0)
    v_max3_u32 v16, v8, v9, v10
    v_max3_u32 v16, v16, v11, v12
    v_max3_u32 v16, v16, v13, v14
    v_max_u32 v16, v16, v15
    v_cmp_eq_u32 vcc, -1, v16
    s_nop 3
    s_cmp_eq_u64 vcc, 0
    s_cbranch_scc1 Lf76
    s_mov_b64 exec, vcc
    s_add_u32 s59, s59, 1
    s_cmp_gt_u32 s59, 131072
    s_cbranch_scc1 Lf76
    s_sleep 8
    s_branch Ld75
Lf76:
    s_mov_b64 exec, -1
    ds_write_b128 v7, v[12:15] offset:4096
    s_branch gated_mix__ssm_conv_s4__spectral_gfnet__prompt_kernel_t_a2
gated_mix__ssm_conv_s4__spectral_gfnet__prompt_kernel_t_a1:
    s_mov_b32 s59, 0
Ld77:
    global_load_dwordx4 v[8:11], v5, s[24:25] sc1
    s_waitcnt vmcnt(0)
    v_max3_u32 v16, v8, v9, v10
    v_max_u32 v16, v16, v11
    v_cmp_eq_u32 vcc, -1, v16
    s_nop 3
    s_cmp_eq_u64 vcc, 0
    s_cbranch_scc1 Lf78
    s_mov_b64 exec, vcc
    s_add_u32 s59, s59, 1
    s_cmp_gt_u32 s59, 131072
    s_cbranch_scc1 Lf78
    s_sleep 8
    s_branch Ld77
Lf78:
    s_mov_b64 exec, -1
gated_mix__ssm_conv_s4__spectral_gfnet__prompt_kernel_t_a2:
    ds_write_b128 v7, v[8:11]
    s_waitcnt lgkmcnt(0)
    s_mov_b64 exec, 1
    ds_add_u32 v127, v126 offset:32
    s_mov_b64 exec, -1
    s_endpgm
gated_mix__ssm_conv_s4__spectral_gfnet__prompt_kernel_end:
    s_endpgm
gated_mix__ssm_conv_s4__spectral_gfnet__prompt_kernel_codeend:
.section .rodata,"a"
.p2align 6
.amdhsa_kernel gated_mix__ssm_conv_s4__spectral_gfnet__prompt_kernel
  .amdhsa_next_free_vgpr 128
  .amdhsa_next_free_sgpr 96
  .amdhsa_accum_offset 128
  .amdhsa_group_segment_fixed_size 0
  .amdhsa_kernarg_size 128
  .amdhsa_user_sgpr_count 2
  .amdhsa_user_sgpr_kernarg_segment_ptr 1
  .amdhsa_system_sgpr_workgroup_id_x 1
  .amdhsa_float_denorm_mode_32 3
.end_amdhsa_kernel
.text
```
